```python
import torch

def _softmax(x, axis=-1):
    return torch.softmax(x, dim=axis)
def _gelu(x):
    return torch.nn.functional.gelu(x, approximate="tanh")
def _silu(x):
    return torch.nn.functional.silu(x)
def _sigmoid(x):
    return torch.sigmoid(x)
def _layernorm(x, axis=-1, eps=1e-5):
    m = x.mean(dim=axis, keepdim=True)
    v = x.var(dim=axis, keepdim=True, unbiased=False)
    return (x - m) / torch.sqrt(v + eps)
def _scatter_add(tgt, idx, src, axis=0):
    return tgt.clone().index_add_(axis, idx, src)
def _segment_sum(src, seg, n):
    out = torch.zeros((n,) + src.shape[1:], dtype=src.dtype)
    return out.index_add_(0, seg, src)
def _pad(x, pw):
    flat = tuple(v for pair in reversed(pw) for v in pair)
    return torch.nn.functional.pad(x, flat)

kernel_name = 'standalone__gqa_block_cached__sampling'

def setup_inputs():

    _w = (lambda a: (lambda t: t.to(torch.bfloat16) if t.is_floating_point() else t)(torch.as_tensor(a)))
    B, Sq, D = 8, 1, 512
    Hq, Hkv, Sk, Dh = 32, 8, 8192, 128
    assert Hq % Hkv == 0, (Hq, Hkv)
    return {
        "x": _w((lambda *s: torch.randn(*s, dtype=torch.bfloat16) * 0.8)(B, Sq, D)),
        "k_cache": _w((lambda *s: torch.randn(*s, dtype=torch.bfloat16) * 0.8)(B, Hkv, Sk, Dh)),
        "v_cache": _w((lambda *s: torch.randn(*s, dtype=torch.bfloat16) * 0.05)(B, Hkv, Sk, Dh)),
        "wq": _w((lambda *s: torch.randn(*s, dtype=torch.bfloat16) * 0.8)(D, Hq * Dh) * (D ** -0.5)),
        "wo": _w((lambda *s: torch.randn(*s, dtype=torch.bfloat16) * 0.05)(Hq * Dh, D) * ((Hq * Dh) ** -0.5)),
    }

def reference(x, k_cache, v_cache, wq, wo):
    B, Sq, D = x.shape
    Hq, Dh = 32, 128
    Hkv = k_cache.shape[1]
    rep = Hq // Hkv
    q = (lambda x, *d: x.permute(*d))((x @ wq).reshape(B, Sq, Hq, Dh), 0, 2, 1, 3)
    k = (lambda x, n, axis: torch.repeat_interleave(x, n, dim=axis))(k_cache, rep, axis=1)
    v = (lambda x, n, axis: torch.repeat_interleave(x, n, dim=axis))(v_cache, rep, axis=1)
    scores = torch.einsum("bhqd,bhkd->bhqk", q, k) * (Dh ** -0.5)
    p = _softmax(scores, axis=-1)
    o = torch.einsum("bhqk,bhkd->bhqd", p, v)
    return (lambda x, *d: x.permute(*d))(o, 0, 2, 1, 3).reshape(B, Sq, Hq * Dh) @ wo
```

```asm
; @launch grid=(256,1,1) block=(256,1,1) lds=99392
.amdgcn_target "amdgcn-amd-amdhsa--gfx950"
.text
    .p2align 8
    .globl standalone__gqa_block_cached__sampling_kernel
    .type standalone__gqa_block_cached__sampling_kernel,@function
standalone__gqa_block_cached__sampling_kernel:
    s_cmp_ge_u32 s2, 256
    s_cbranch_scc1 L_end_standalone__gqa_block_cached__sampling_kernel
    s_load_dwordx16 s[32:47], s[0:1], 0
    v_lshrrev_b32 v7, 6, v0
    v_and_b32 v1, 63, v0
    v_readfirstlane_b32 s3, v7
    s_and_b32 s24, s2, 7
    s_lshr_b32 s25, s2, 3
    s_lshr_b32 s26, s25, 2
    s_and_b32 s27, s25, 3
    s_lshl_b32 s28, s26, 3
    s_add_u32 s28, s28, s24
    s_lshl_b32 s29, s28, 21
    s_lshl_b32 s30, s25, 16
    v_mov_b32 v11, 99328
    v_mov_b32 v16, 10
    v_mov_b32 v17, 1
    v_mov_b32 v18, 0
    v_mov_b32 v19, 0
    v_mov_b32 v20, 0
    v_mov_b32 v21, 0
    ds_write_b128 v11, v[16:19]
    ds_write_b128 v11, v[18:21] offset:16
    v_mov_b32 v22, 0xff7fffff
    v_mov_b32 v23, 0xff7fffff
    ds_write_b64 v11, v[22:23] offset:32
    ds_write_b64 v11, v[22:23] offset:40
    v_and_b32 v7, 3, v1
    v_lshlrev_b32 v7, 10, v7
    v_bfe_u32 v8, v1, 2, 2
    v_lshl_add_u32 v7, v8, 8, v7
    v_lshrrev_b32 v8, 4, v1
    v_lshl_add_u32 v2, v8, 4, v7
    v_lshlrev_b32 v3, 4, v1
    s_lshl_b32 s68, s24, 18
    s_add_u32 s68, s68, 2097152
    s_cmp_lg_u32 s3, 0
    s_cbranch_scc1 L_pre_standalone__gqa_block_cached__sampling_kernel
    s_and_b32 s76, s25, 3
    s_lshr_b32 s77, s25, 2
    v_lshrrev_b32 v7, 3, v1
    v_and_b32 v10, 7, v1
    v_lshlrev_b32 v10, 4, v10
    v_lshl_add_u32 v9, v7, 13, v10
    v_and_b32 v8, 7, v1
    v_lshlrev_b32 v8, 10, v8
    v_lshrrev_b32 v7, 4, v1
    v_lshl_add_u32 v8, v7, 4, v8
    s_lshl_b32 s57, s24, 10
    s_mul_i32 s58, s77, 128
    s_add_u32 s57, s57, s58
    s_mul_i32 s58, s76, 1048576
    s_add_u32 s57, s57, s58
    s_mul_i32 s59, s76, 256
    s_mov_b32 m0, 0
    v_mov_b32 v56, -1
    v_mov_b32 v57, -1
    v_mov_b32 v58, -1
    v_mov_b32 v59, -1
    s_lshl_b32 s50, s25, 4
    s_sub_u32 s50, 1024, s50
    v_mov_b32 v60, v3
    v_writelane_b32 v60, s50, 2
    s_lshl_b32 s48, s25, 11
    s_add_u32 s48, s48, s68
    s_add_u32 s48, s48, 131072
    s_lshl_b32 s49, s25, 5
    s_add_u32 s49, s49, s68
    s_add_u32 s49, s49, 196608
    s_getreg_b32 s62, hwreg(HW_REG_XCC_ID)
    s_waitcnt lgkmcnt(0)
    s_mov_b32 s16, s38
    s_and_b32 s17, s39, 0xffff
    s_mov_b32 s18, 0x400000
    s_mov_b32 s19, 0x20000
    s_mov_b32 s20, s32
    s_and_b32 s21, s33, 0xffff
    s_mov_b32 s22, 0x2000
    s_mov_b32 s23, 0x20000
    s_load_dwordx2 s[52:53], s[46:47], 0
    buffer_load_dwordx4 v[112:115], v8, s[20:23], s59 offen offset:0
    buffer_load_dwordx4 v[116:119], v8, s[20:23], s59 offen offset:64
    buffer_load_dwordx4 v[120:123], v8, s[20:23], s59 offen offset:128
    buffer_load_dwordx4 v[124:127], v8, s[20:23], s59 offen offset:192
    buffer_load_dwordx4 v9, s[16:19], s57 offen nt lds
    s_add_u32 m0, m0, 1024
    s_add_u32 s57, s57, 65536
    buffer_load_dwordx4 v9, s[16:19], s57 offen nt lds
    s_add_u32 m0, m0, 1024
    s_add_u32 s57, s57, 65536
    buffer_load_dwordx4 v9, s[16:19], s57 offen nt lds
    s_add_u32 m0, m0, 1024
    s_add_u32 s57, s57, 65536
    buffer_load_dwordx4 v9, s[16:19], s57 offen nt lds
    s_add_u32 m0, m0, 1024
    s_add_u32 s57, s57, 65536
    buffer_load_dwordx4 v9, s[16:19], s57 offen nt lds
    s_add_u32 m0, m0, 1024
    s_add_u32 s57, s57, 65536
    buffer_load_dwordx4 v9, s[16:19], s57 offen nt lds
    s_add_u32 m0, m0, 1024
    s_add_u32 s57, s57, 65536
    buffer_load_dwordx4 v9, s[16:19], s57 offen nt lds
    s_add_u32 m0, m0, 1024
    s_add_u32 s57, s57, 65536
    buffer_load_dwordx4 v9, s[16:19], s57 offen nt lds
    s_add_u32 m0, m0, 1024
    s_add_u32 s57, s57, 65536
    buffer_load_dwordx4 v9, s[16:19], s57 offen nt lds
    s_add_u32 m0, m0, 1024
    s_add_u32 s57, s57, 65536
    buffer_load_dwordx4 v9, s[16:19], s57 offen nt lds
    s_add_u32 m0, m0, 1024
    s_add_u32 s57, s57, 65536
    buffer_load_dwordx4 v9, s[16:19], s57 offen nt lds
    s_add_u32 m0, m0, 1024
    s_add_u32 s57, s57, 65536
    buffer_load_dwordx4 v9, s[16:19], s57 offen nt lds
    s_add_u32 m0, m0, 1024
    s_add_u32 s57, s57, 65536
    buffer_load_dwordx4 v9, s[16:19], s57 offen nt lds
    s_add_u32 m0, m0, 1024
    s_add_u32 s57, s57, 65536
    buffer_load_dwordx4 v9, s[16:19], s57 offen nt lds
    s_add_u32 m0, m0, 1024
    s_add_u32 s57, s57, 65536
    buffer_load_dwordx4 v9, s[16:19], s57 offen nt lds
    s_add_u32 m0, m0, 1024
    s_add_u32 s57, s57, 65536
    buffer_load_dwordx4 v9, s[16:19], s57 offen nt lds
    s_mov_b32 s4, s34
    s_and_b32 s5, s35, 0xffff
    s_mov_b32 s6, 0x8000000
    s_mov_b32 s7, 0x20000
    s_mov_b32 s8, s36
    s_and_b32 s9, s37, 0xffff
    s_mov_b32 s10, 0x8000000
    s_mov_b32 s11, 0x20000
    s_mov_b32 s12, s46
    s_and_b32 s13, s47, 0xffff
    s_mov_b32 s14, 0x600000
    s_mov_b32 s15, 0x20000
    buffer_store_dwordx4 v[56:59], v3, s[12:15], s48 offen sc1
    buffer_store_dwordx4 v[56:59], v3, s[12:15], s48 offen offset:1024 sc1
    s_mov_b64 exec, 7
    buffer_store_dwordx4 v[56:59], v60, s[12:15], s49 offen sc1
    s_mov_b64 exec, -1
    s_barrier
    s_mov_b32 s54, 0x3e0293ee
    s_mov_b32 s55, 0x05040100
    s_mov_b32 s56, 0x07060302
    s_mov_b32 s69, 0
    v_mov_b32 v6, 0
    v_mov_b32 v12, 1
    v_mov_b32 v80, 0
    v_mov_b32 v81, 0
    v_mov_b32 v82, 0
    v_mov_b32 v83, 0
    v_mov_b32 v84, 0
    v_mov_b32 v85, 0
    v_mov_b32 v86, 0
    v_mov_b32 v87, 0
    v_mov_b32 v88, 0
    v_mov_b32 v89, 0
    v_mov_b32 v90, 0
    v_mov_b32 v91, 0
    v_mov_b32 v92, 0
    v_mov_b32 v93, 0
    v_mov_b32 v94, 0
    v_mov_b32 v95, 0
    v_mov_b32 v96, 0
    v_mov_b32 v97, 0
    v_mov_b32 v98, 0
    v_mov_b32 v99, 0
    v_mov_b32 v100, 0
    v_mov_b32 v101, 0
    v_mov_b32 v102, 0
    v_mov_b32 v103, 0
    v_mov_b32 v104, 0
    v_mov_b32 v105, 0
    v_mov_b32 v106, 0
    v_mov_b32 v107, 0
    v_mov_b32 v108, 0
    v_mov_b32 v109, 0
    v_mov_b32 v110, 0
    v_mov_b32 v111, 0
    s_add_u32 s70, s46, s68
    s_addc_u32 s71, s47, 0
    v_bfe_u32 v64, v1, 2, 1
    v_lshl_add_u32 v248, v64, 10, v3
    v_xor_b32 v249, 0x400, v248
    v_cmp_eq_u32 vcc, 1, v64
    v_mov_b32 v65, 0x05040100
    v_mov_b32 v66, 0x01000504
    v_cndmask_b32 v250, v65, v66, vcc
    v_add_u32 v251, 0x02020202, v250
    v_lshrrev_b32 v65, 4, v1
    v_and_b32 v67, 3, v1
    v_lshlrev_b32 v252, 4, v67
    v_lshl_add_u32 v252, v65, 6, v252
    v_add_u32 v252, 65536, v252
    v_lshl_add_u32 v253, v67, 2, v11
    s_lshl_b32 s60, s3, 14
    v_and_b32 v66, 15, v1
    v_lshlrev_b32 v64, 2, v65
    v_xor_b32 v64, v64, v66
    v_lshlrev_b32 v67, 10, v67
    v_bfe_u32 v68, v1, 2, 2
    v_lshl_add_u32 v67, v68, 8, v67
    v_add_u32 v67, s60, v67
    v_xor_b32 v66, v65, v66
    v_lshlrev_b32 v65, 8, v65
    v_add_u32 v65, s60, v65
    v_xor_b32 v68, 0, v64
    v_lshl_add_u32 v240, v68, 4, v65
    v_xor_b32 v68, 0, v66
    v_lshl_add_u32 v244, v68, 4, v67
    v_xor_b32 v68, 1, v64
    v_lshl_add_u32 v241, v68, 4, v65
    v_xor_b32 v68, 4, v66
    v_lshl_add_u32 v245, v68, 4, v67
    v_xor_b32 v68, 2, v64
    v_lshl_add_u32 v242, v68, 4, v65
    v_xor_b32 v68, 8, v66
    v_lshl_add_u32 v246, v68, 4, v67
    v_xor_b32 v68, 3, v64
    v_lshl_add_u32 v243, v68, 4, v65
    v_xor_b32 v68, 12, v66
    v_lshl_add_u32 v247, v68, 4, v67
    v_bfe_u32 v7, v1, 2, 2
    v_lshrrev_b32 v8, 4, v1
    v_lshl_add_u32 v7, v8, 3, v7
    v_mul_u32_u24 v7, 128, v7
    v_and_b32 v8, 3, v1
    v_lshl_add_u32 v7, v8, 3, v7
    v_lshrrev_b32 v61, 4, v1
    v_mul_u32_u24 v61, 8192, v61
    v_and_b32 v8, 15, v1
    v_lshl_add_u32 v61, v8, 4, v61
    s_lshl_b32 s72, s76, 11
    s_mul_i32 s58, s77, 256
    s_add_u32 s72, s72, s58
    s_add_u32 s72, s72, s68
    s_add_u32 s73, s72, 32768
    s_waitcnt vmcnt(15)
    ds_read_b64_tr_b16 v[176:177], v7 offset:0
    ds_read_b64_tr_b16 v[178:179], v7 offset:512
    ds_read_b64_tr_b16 v[180:181], v7 offset:32
    ds_read_b64_tr_b16 v[182:183], v7 offset:544
    ds_read_b64_tr_b16 v[184:185], v7 offset:64
    ds_read_b64_tr_b16 v[186:187], v7 offset:576
    ds_read_b64_tr_b16 v[188:189], v7 offset:96
    ds_read_b64_tr_b16 v[190:191], v7 offset:608
    s_waitcnt vmcnt(11)
    ds_read_b64_tr_b16 v[192:193], v7 offset:4096
    ds_read_b64_tr_b16 v[194:195], v7 offset:4608
    ds_read_b64_tr_b16 v[196:197], v7 offset:4128
    ds_read_b64_tr_b16 v[198:199], v7 offset:4640
    ds_read_b64_tr_b16 v[200:201], v7 offset:4160
    ds_read_b64_tr_b16 v[202:203], v7 offset:4672
    ds_read_b64_tr_b16 v[204:205], v7 offset:4192
    ds_read_b64_tr_b16 v[206:207], v7 offset:4704
    s_waitcnt lgkmcnt(8)
    v_mfma_f32_16x16x32_bf16 v[32:35], v[176:179], v[112:115], 0
    v_mfma_f32_16x16x32_bf16 v[36:39], v[180:183], v[112:115], 0
    v_mfma_f32_16x16x32_bf16 v[40:43], v[184:187], v[112:115], 0
    v_mfma_f32_16x16x32_bf16 v[44:47], v[188:191], v[112:115], 0
    s_waitcnt vmcnt(7)
    ds_read_b64_tr_b16 v[208:209], v7 offset:8192
    ds_read_b64_tr_b16 v[210:211], v7 offset:8704
    ds_read_b64_tr_b16 v[212:213], v7 offset:8224
    ds_read_b64_tr_b16 v[214:215], v7 offset:8736
    ds_read_b64_tr_b16 v[216:217], v7 offset:8256
    ds_read_b64_tr_b16 v[218:219], v7 offset:8768
    ds_read_b64_tr_b16 v[220:221], v7 offset:8288
    ds_read_b64_tr_b16 v[222:223], v7 offset:8800
    s_waitcnt lgkmcnt(8)
    v_mfma_f32_16x16x32_bf16 v[32:35], v[192:195], v[116:119], v[32:35]
    v_mfma_f32_16x16x32_bf16 v[36:39], v[196:199], v[116:119], v[36:39]
    v_mfma_f32_16x16x32_bf16 v[40:43], v[200:203], v[116:119], v[40:43]
    v_mfma_f32_16x16x32_bf16 v[44:47], v[204:207], v[116:119], v[44:47]
    s_waitcnt vmcnt(3)
    ds_read_b64_tr_b16 v[224:225], v7 offset:12288
    ds_read_b64_tr_b16 v[226:227], v7 offset:12800
    ds_read_b64_tr_b16 v[228:229], v7 offset:12320
    ds_read_b64_tr_b16 v[230:231], v7 offset:12832
    ds_read_b64_tr_b16 v[232:233], v7 offset:12352
    ds_read_b64_tr_b16 v[234:235], v7 offset:12864
    ds_read_b64_tr_b16 v[236:237], v7 offset:12384
    ds_read_b64_tr_b16 v[238:239], v7 offset:12896
    s_waitcnt lgkmcnt(8)
    v_mfma_f32_16x16x32_bf16 v[32:35], v[208:211], v[120:123], v[32:35]
    v_mfma_f32_16x16x32_bf16 v[36:39], v[212:215], v[120:123], v[36:39]
    v_mfma_f32_16x16x32_bf16 v[40:43], v[216:219], v[120:123], v[40:43]
    v_mfma_f32_16x16x32_bf16 v[44:47], v[220:223], v[120:123], v[44:47]
    s_waitcnt lgkmcnt(0)
    v_mfma_f32_16x16x32_bf16 v[32:35], v[224:227], v[124:127], v[32:35]
    v_mfma_f32_16x16x32_bf16 v[36:39], v[228:231], v[124:127], v[36:39]
    v_mfma_f32_16x16x32_bf16 v[40:43], v[232:235], v[124:127], v[40:43]
    v_mfma_f32_16x16x32_bf16 v[44:47], v[236:239], v[124:127], v[44:47]
    s_add_u32 s52, s52, 1
    s_add_u32 s53, s53, 0x9e3779b1
    s_and_b32 s44, s52, 0x3ff
    s_bfe_u32 s45, s52, 0xa000a
    s_lshr_b32 s33, s0, 6
    s_xor_b32 s33, s33, s53
    s_and_b32 s32, s33, 0x3ff
    s_bfe_u32 s33, s33, 0xa000a
    s_mov_b32 s38, 0xfffffc00
    s_and_b32 s62, s62, 15
    s_andn2_b32 s63, s33, 15
    s_or_b32 s63, s63, s62
    v_and_b32 v8, 7, v1
    v_lshlrev_b32 v8, 8, v8
    v_lshrrev_b32 v10, 4, v1
    v_lshl_add_u32 v8, v10, 4, v8
    v_add_u32 v8, 65536, v8
    v_add_u32 v10, 65536, v3
    s_mov_b32 exec_lo, 0x00ff00ff
    s_mov_b32 exec_hi, 0x00ff00ff
    ds_write_b128 v8, v[32:35] offset:0
    ds_write_b128 v8, v[36:39] offset:64
    ds_write_b128 v8, v[40:43] offset:128
    ds_write_b128 v8, v[44:47] offset:192
    s_mov_b64 exec, -1
    ds_read_b128 v[16:19], v10 offset:0
    ds_read_b128 v[20:23], v10 offset:1024
    v_mov_b32 v24, s44
    v_mov_b32 v25, s45
    v_mov_b32 v26, s32
    v_mov_b32 v27, s63
    s_waitcnt lgkmcnt(0)
    v_add_u32 v16, 0x200, v16
    v_and_or_b32 v16, v16, s38, v24
    v_add_u32 v17, 0x200, v17
    v_and_or_b32 v17, v17, s38, v25
    v_add_u32 v18, 0x200, v18
    v_and_or_b32 v18, v18, s38, v26
    v_add_u32 v19, 0x200, v19
    v_and_or_b32 v19, v19, s38, v27
    v_add_u32 v20, 0x200, v20
    v_and_or_b32 v20, v20, s38, v24
    v_add_u32 v21, 0x200, v21
    v_and_or_b32 v21, v21, s38, v25
    v_add_u32 v22, 0x200, v22
    v_and_or_b32 v22, v22, s38, v26
    v_add_u32 v23, 0x200, v23
    v_and_or_b32 v23, v23, s38, v27
    s_waitcnt vmcnt(0) lgkmcnt(0)
    buffer_store_dwordx4 v[16:19], v61, s[12:15], s72 offen
    buffer_store_dwordx4 v[20:23], v61, s[12:15], s73 offen
    s_xor_b32 s72, s72, 6291456
    s_xor_b32 s73, s73, 6291456
    s_mul_i32 s57, s26, 8192
    s_add_u32 s48, s57, s68
    s_mov_b32 s60, 0
    s_waitcnt vmcnt(0)
L_qpoll_standalone__gqa_block_cached__sampling_kernel:
    s_add_u32 s49, s48, 4096
    buffer_load_dwordx4 v[112:115], v3, s[12:15], s48 offen offset:0 sc1
    buffer_load_dwordx4 v[116:119], v3, s[12:15], s48 offen offset:1024 sc1
    buffer_load_dwordx4 v[120:123], v3, s[12:15], s48 offen offset:2048 sc1
    buffer_load_dwordx4 v[124:127], v3, s[12:15], s48 offen offset:3072 sc1
    buffer_load_dwordx4 v[128:131], v3, s[12:15], s49 offen offset:0 sc1
    buffer_load_dwordx4 v[132:135], v3, s[12:15], s49 offen offset:1024 sc1
    buffer_load_dwordx4 v[136:139], v3, s[12:15], s49 offen offset:2048 sc1
    buffer_load_dwordx4 v[140:143], v3, s[12:15], s49 offen offset:3072 sc1
    s_add_u32 s60, s60, 1
    v_mov_b32 v7, 0
    v_mov_b32 v8, 0
    s_waitcnt vmcnt(6)
    v_xor_b32 v112, s44, v112
    v_xor_b32 v113, s45, v113
    v_xor_b32 v114, s32, v114
    v_xor_b32 v115, s63, v115
    v_or3_b32 v7, v7, v112, v113
    v_or_b32 v7, v7, v114
    v_or_b32 v8, v8, v115
    v_xor_b32 v116, s44, v116
    v_xor_b32 v117, s45, v117
    v_xor_b32 v118, s32, v118
    v_xor_b32 v119, s63, v119
    v_or3_b32 v7, v7, v116, v117
    v_or_b32 v7, v7, v118
    v_or_b32 v8, v8, v119
    s_waitcnt vmcnt(4)
    v_xor_b32 v120, s44, v120
    v_xor_b32 v121, s45, v121
    v_xor_b32 v122, s32, v122
    v_xor_b32 v123, s63, v123
    v_or3_b32 v7, v7, v120, v121
    v_or_b32 v7, v7, v122
    v_or_b32 v8, v8, v123
    v_xor_b32 v124, s44, v124
    v_xor_b32 v125, s45, v125
    v_xor_b32 v126, s32, v126
    v_xor_b32 v127, s63, v127
    v_or3_b32 v7, v7, v124, v125
    v_or_b32 v7, v7, v126
    v_or_b32 v8, v8, v127
    s_waitcnt vmcnt(2)
    v_xor_b32 v128, s44, v128
    v_xor_b32 v129, s45, v129
    v_xor_b32 v130, s32, v130
    v_xor_b32 v131, s63, v131
    v_or3_b32 v7, v7, v128, v129
    v_or_b32 v7, v7, v130
    v_or_b32 v8, v8, v131
    v_xor_b32 v132, s44, v132
    v_xor_b32 v133, s45, v133
    v_xor_b32 v134, s32, v134
    v_xor_b32 v135, s63, v135
    v_or3_b32 v7, v7, v132, v133
    v_or_b32 v7, v7, v134
    v_or_b32 v8, v8, v135
    s_waitcnt vmcnt(0)
    v_xor_b32 v136, s44, v136
    v_xor_b32 v137, s45, v137
    v_xor_b32 v138, s32, v138
    v_xor_b32 v139, s63, v139
    v_or3_b32 v7, v7, v136, v137
    v_or_b32 v7, v7, v138
    v_or_b32 v8, v8, v139
    v_xor_b32 v140, s44, v140
    v_xor_b32 v141, s45, v141
    v_xor_b32 v142, s32, v142
    v_xor_b32 v143, s63, v143
    v_or3_b32 v7, v7, v140, v141
    v_or_b32 v7, v7, v142
    v_or_b32 v8, v8, v143
    v_and_b32 v10, -16, v8
    v_or_b32 v7, v7, v10
    v_and_b32 v7, 0x3ff, v7
    v_and_b32 v8, 15, v8
    v_cmp_ne_u32 vcc, 0, v7
    s_cbranch_vccz L_qok_standalone__gqa_block_cached__sampling_kernel
    s_cmp_lt_u32 s60, 12
    s_cbranch_scc1 L_qn_standalone__gqa_block_cached__sampling_kernel
    s_xor_b32 s48, s48, 6291456
    s_cmp_lg_u32 s60, 12
    s_cbranch_scc1 L_qn_standalone__gqa_block_cached__sampling_kernel
    buffer_store_dwordx4 v[16:19], v61, s[12:15], s72 offen sc1
    buffer_store_dwordx4 v[20:23], v61, s[12:15], s73 offen sc1
L_qn_standalone__gqa_block_cached__sampling_kernel:
    s_sleep 4
    s_cmp_lt_u32 s60, 524288
    s_cbranch_scc1 L_qpoll_standalone__gqa_block_cached__sampling_kernel
L_qok_standalone__gqa_block_cached__sampling_kernel:
    v_cmp_ne_u32 vcc, 0, v8
    v_and_b32 v115, s38, v115
    v_and_b32 v119, s38, v119
    v_and_b32 v123, s38, v123
    v_and_b32 v127, s38, v127
    v_and_b32 v131, s38, v131
    v_and_b32 v135, s38, v135
    v_and_b32 v139, s38, v139
    v_and_b32 v143, s38, v143
    v_add_f32 v112, v112, v120
    v_add_f32 v113, v113, v121
    v_add_f32 v114, v114, v122
    v_add_f32 v115, v115, v123
    v_add_f32 v116, v116, v124
    v_add_f32 v117, v117, v125
    v_add_f32 v118, v118, v126
    v_add_f32 v119, v119, v127
    v_add_f32 v112, v112, v128
    v_add_f32 v113, v113, v129
    v_add_f32 v114, v114, v130
    v_add_f32 v115, v115, v131
    v_add_f32 v116, v116, v132
    v_add_f32 v117, v117, v133
    v_add_f32 v118, v118, v134
    v_add_f32 v119, v119, v135
    v_add_f32 v112, v112, v136
    v_add_f32 v113, v113, v137
    v_add_f32 v114, v114, v138
    v_add_f32 v115, v115, v139
    v_add_f32 v116, v116, v140
    v_add_f32 v117, v117, v141
    v_add_f32 v118, v118, v142
    v_add_f32 v119, v119, v143
    v_lshlrev_b32 v7, 3, v1
    v_add_u32 v7, 98304, v7
    v_cvt_pk_bf16_f32 v112, v112, v113
    v_cvt_pk_bf16_f32 v113, v114, v115
    ds_write_b64 v7, v[112:113] offset:0
    v_cvt_pk_bf16_f32 v116, v116, v117
    v_cvt_pk_bf16_f32 v117, v118, v119
    ds_write_b64 v7, v[116:117] offset:512
    s_cmp_eq_u64 vcc, 0
    s_cselect_b32 s31, 1, 0
    v_mov_b32 v8, s31
    ds_write_b32 v11, v8 offset:12
    s_cbranch_scc1 L_col_standalone__gqa_block_cached__sampling_kernel
    buffer_store_dwordx4 v[16:19], v61, s[12:15], s72 offen sc1
    buffer_store_dwordx4 v[20:23], v61, s[12:15], s73 offen sc1
    s_nop 1
L_col_standalone__gqa_block_cached__sampling_kernel:
    s_mov_b32 s61, 6
    s_bfe_u32 s57, s61, 0x30001
    s_lshl_b32 s57, s57, 18
    s_and_b32 s58, s61, 1
    s_lshl_b32 s58, s58, 15
    s_add_u32 s57, s57, s58
    s_add_u32 s57, s57, s30
    s_and_b32 s57, s57, 0x1fffff
    s_add_u32 s48, s57, s29
    s_add_u32 s49, s48, 4096
    s_add_u32 s50, s48, 8192
    s_add_u32 s51, s48, 12288
    s_add_u32 s80, s48, 16384
    s_add_u32 s81, s48, 20480
    s_add_u32 s82, s48, 24576
    s_add_u32 s83, s48, 28672
    s_waitcnt lgkmcnt(0)
    s_barrier
    buffer_load_dwordx4 a[0:3], v2, s[4:7], s48 offen offset:0 nt
    buffer_load_dwordx4 a[4:7], v2, s[4:7], s48 offen offset:64 nt
    buffer_load_dwordx4 a[8:11], v2, s[4:7], s48 offen offset:128 nt
    buffer_load_dwordx4 a[12:15], v2, s[4:7], s48 offen offset:192 nt
    buffer_load_dwordx4 v[112:115], v3, s[4:7], s49 offen offset:0 nt
    buffer_load_dwordx4 v[116:119], v3, s[4:7], s49 offen offset:1024 nt
    buffer_load_dwordx4 v[120:123], v3, s[4:7], s49 offen offset:2048 nt
    buffer_load_dwordx4 v[124:127], v3, s[4:7], s49 offen offset:3072 nt
    buffer_load_dwordx4 a[16:19], v2, s[4:7], s50 offen offset:0 nt
    buffer_load_dwordx4 a[20:23], v2, s[4:7], s50 offen offset:64 nt
    buffer_load_dwordx4 a[24:27], v2, s[4:7], s50 offen offset:128 nt
    buffer_load_dwordx4 a[28:31], v2, s[4:7], s50 offen offset:192 nt
    buffer_load_dwordx4 v[128:131], v3, s[4:7], s51 offen offset:0 nt
    buffer_load_dwordx4 v[132:135], v3, s[4:7], s51 offen offset:1024 nt
    buffer_load_dwordx4 v[136:139], v3, s[4:7], s51 offen offset:2048 nt
    buffer_load_dwordx4 v[140:143], v3, s[4:7], s51 offen offset:3072 nt
    buffer_load_dwordx4 a[32:35], v2, s[4:7], s80 offen offset:0 nt
    buffer_load_dwordx4 a[36:39], v2, s[4:7], s80 offen offset:64 nt
    buffer_load_dwordx4 a[40:43], v2, s[4:7], s80 offen offset:128 nt
    buffer_load_dwordx4 a[44:47], v2, s[4:7], s80 offen offset:192 nt
    buffer_load_dwordx4 v[144:147], v3, s[4:7], s81 offen offset:0 nt
    buffer_load_dwordx4 v[148:151], v3, s[4:7], s81 offen offset:1024 nt
    buffer_load_dwordx4 v[152:155], v3, s[4:7], s81 offen offset:2048 nt
    buffer_load_dwordx4 v[156:159], v3, s[4:7], s81 offen offset:3072 nt
    buffer_load_dwordx4 a[48:51], v2, s[4:7], s82 offen offset:0 nt
    buffer_load_dwordx4 a[52:55], v2, s[4:7], s82 offen offset:64 nt
    buffer_load_dwordx4 a[56:59], v2, s[4:7], s82 offen offset:128 nt
    buffer_load_dwordx4 a[60:63], v2, s[4:7], s82 offen offset:192 nt
    buffer_load_dwordx4 v[160:163], v3, s[4:7], s83 offen offset:0 nt
    buffer_load_dwordx4 v[164:167], v3, s[4:7], s83 offen offset:1024 nt
    buffer_load_dwordx4 v[168:171], v3, s[4:7], s83 offen offset:2048 nt
    buffer_load_dwordx4 v[172:175], v3, s[4:7], s83 offen offset:3072 nt
    s_branch L_getq_standalone__gqa_block_cached__sampling_kernel
L_pre_standalone__gqa_block_cached__sampling_kernel:
    s_sub_u32 s61, s3, 1
    s_lshl_b32 s61, s61, 1
    s_bfe_u32 s57, s61, 0x30001
    s_lshl_b32 s57, s57, 18
    s_and_b32 s58, s61, 1
    s_lshl_b32 s58, s58, 15
    s_add_u32 s57, s57, s58
    s_add_u32 s57, s57, s30
    s_and_b32 s57, s57, 0x1fffff
    s_add_u32 s48, s57, s29
    s_add_u32 s49, s48, 4096
    s_add_u32 s50, s48, 8192
    s_add_u32 s51, s48, 12288
    s_add_u32 s80, s48, 16384
    s_add_u32 s81, s48, 20480
    s_add_u32 s82, s48, 24576
    s_add_u32 s83, s48, 28672
    s_waitcnt lgkmcnt(0)
    s_mov_b32 s4, s34
    s_and_b32 s5, s35, 0xffff
    s_mov_b32 s6, 0x8000000
    s_mov_b32 s7, 0x20000
    s_mov_b32 s8, s36
    s_and_b32 s9, s37, 0xffff
    s_mov_b32 s10, 0x8000000
    s_mov_b32 s11, 0x20000
    s_mov_b32 s12, s46
    s_and_b32 s13, s47, 0xffff
    s_mov_b32 s14, 0x600000
    s_mov_b32 s15, 0x20000
    s_load_dwordx2 s[52:53], s[46:47], 0
    s_barrier
    s_cmp_eq_u32 s3, 1
    s_cbranch_scc1 L_seqok_standalone__gqa_block_cached__sampling_kernel
    s_mov_b32 s60, 2097152
L_seq_standalone__gqa_block_cached__sampling_kernel:
    ds_read_b32 v7, v11 offset:4
    s_sub_u32 s60, s60, 1
    s_waitcnt lgkmcnt(0)
    v_readfirstlane_b32 s59, v7
    s_cmp_ge_u32 s59, s3
    s_cbranch_scc1 L_seqok_standalone__gqa_block_cached__sampling_kernel
    s_sleep 1
    s_cmp_lg_u32 s60, 0
    s_cbranch_scc1 L_seq_standalone__gqa_block_cached__sampling_kernel
L_seqok_standalone__gqa_block_cached__sampling_kernel:
    s_add_u32 s59, s3, 1
    v_mov_b32 v10, s59
    buffer_load_dwordx4 a[0:3], v2, s[4:7], s48 offen offset:0 nt
    buffer_load_dwordx4 a[4:7], v2, s[4:7], s48 offen offset:64 nt
    buffer_load_dwordx4 a[8:11], v2, s[4:7], s48 offen offset:128 nt
    buffer_load_dwordx4 a[12:15], v2, s[4:7], s48 offen offset:192 nt
    buffer_load_dwordx4 v[112:115], v3, s[4:7], s49 offen offset:0 nt
    buffer_load_dwordx4 v[116:119], v3, s[4:7], s49 offen offset:1024 nt
    buffer_load_dwordx4 v[120:123], v3, s[4:7], s49 offen offset:2048 nt
    buffer_load_dwordx4 v[124:127], v3, s[4:7], s49 offen offset:3072 nt
    s_mov_b32 s54, 0x3e0293ee
    s_mov_b32 s55, 0x05040100
    s_mov_b32 s56, 0x07060302
    s_mov_b32 s69, 0
    v_mov_b32 v6, 0
    v_mov_b32 v12, 1
    v_mov_b32 v80, 0
    v_mov_b32 v81, 0
    v_mov_b32 v82, 0
    v_mov_b32 v83, 0
    v_mov_b32 v84, 0
    v_mov_b32 v85, 0
    buffer_load_dwordx4 a[16:19], v2, s[4:7], s50 offen offset:0 nt
    buffer_load_dwordx4 a[20:23], v2, s[4:7], s50 offen offset:64 nt
    buffer_load_dwordx4 a[24:27], v2, s[4:7], s50 offen offset:128 nt
    buffer_load_dwordx4 a[28:31], v2, s[4:7], s50 offen offset:192 nt
    buffer_load_dwordx4 v[128:131], v3, s[4:7], s51 offen offset:0 nt
    buffer_load_dwordx4 v[132:135], v3, s[4:7], s51 offen offset:1024 nt
    buffer_load_dwordx4 v[136:139], v3, s[4:7], s51 offen offset:2048 nt
    buffer_load_dwordx4 v[140:143], v3, s[4:7], s51 offen offset:3072 nt
    v_mov_b32 v86, 0
    v_mov_b32 v87, 0
    v_mov_b32 v88, 0
    v_mov_b32 v89, 0
    v_mov_b32 v90, 0
    v_mov_b32 v91, 0
    v_mov_b32 v92, 0
    v_mov_b32 v93, 0
    v_mov_b32 v94, 0
    v_mov_b32 v95, 0
    v_mov_b32 v96, 0
    v_mov_b32 v97, 0
    buffer_load_dwordx4 a[32:35], v2, s[4:7], s80 offen offset:0 nt
    buffer_load_dwordx4 a[36:39], v2, s[4:7], s80 offen offset:64 nt
    buffer_load_dwordx4 a[40:43], v2, s[4:7], s80 offen offset:128 nt
    buffer_load_dwordx4 a[44:47], v2, s[4:7], s80 offen offset:192 nt
    buffer_load_dwordx4 v[144:147], v3, s[4:7], s81 offen offset:0 nt
    buffer_load_dwordx4 v[148:151], v3, s[4:7], s81 offen offset:1024 nt
    buffer_load_dwordx4 v[152:155], v3, s[4:7], s81 offen offset:2048 nt
    buffer_load_dwordx4 v[156:159], v3, s[4:7], s81 offen offset:3072 nt
    v_mov_b32 v98, 0
    v_mov_b32 v99, 0
    v_mov_b32 v100, 0
    v_mov_b32 v101, 0
    v_mov_b32 v102, 0
    v_mov_b32 v103, 0
    v_mov_b32 v104, 0
    v_mov_b32 v105, 0
    v_mov_b32 v106, 0
    v_mov_b32 v107, 0
    v_mov_b32 v108, 0
    v_mov_b32 v109, 0
    buffer_load_dwordx4 a[48:51], v2, s[4:7], s82 offen offset:0 nt
    buffer_load_dwordx4 a[52:55], v2, s[4:7], s82 offen offset:64 nt
    buffer_load_dwordx4 a[56:59], v2, s[4:7], s82 offen offset:128 nt
    buffer_load_dwordx4 a[60:63], v2, s[4:7], s82 offen offset:192 nt
    buffer_load_dwordx4 v[160:163], v3, s[4:7], s83 offen offset:0 nt
    buffer_load_dwordx4 v[164:167], v3, s[4:7], s83 offen offset:1024 nt
    buffer_load_dwordx4 v[168:171], v3, s[4:7], s83 offen offset:2048 nt
    buffer_load_dwordx4 v[172:175], v3, s[4:7], s83 offen offset:3072 nt
    s_add_u32 s61, s61, 1
    s_bfe_u32 s57, s61, 0x30001
    s_lshl_b32 s57, s57, 18
    s_and_b32 s58, s61, 1
    s_lshl_b32 s58, s58, 15
    s_add_u32 s57, s57, s58
    s_add_u32 s57, s57, s30
    s_and_b32 s57, s57, 0x1fffff
    s_add_u32 s48, s57, s29
    s_add_u32 s49, s48, 4096
    s_add_u32 s50, s48, 8192
    s_add_u32 s51, s48, 12288
    s_add_u32 s80, s48, 16384
    s_add_u32 s81, s48, 20480
    s_add_u32 s82, s48, 24576
    s_add_u32 s83, s48, 28672
    buffer_load_dwordx4 a[64:67], v3, s[4:7], s48 offen offset:0 nt
    buffer_load_dwordx4 a[68:71], v3, s[4:7], s48 offen offset:1024 nt
    buffer_load_dwordx4 a[72:75], v3, s[4:7], s48 offen offset:2048 nt
    buffer_load_dwordx4 a[76:79], v3, s[4:7], s48 offen offset:3072 nt
    buffer_load_dwordx4 v[176:179], v3, s[4:7], s49 offen offset:0 nt
    buffer_load_dwordx4 v[180:183], v3, s[4:7], s49 offen offset:1024 nt
    buffer_load_dwordx4 v[184:187], v3, s[4:7], s49 offen offset:2048 nt
    buffer_load_dwordx4 v[188:191], v3, s[4:7], s49 offen offset:3072 nt
    v_mov_b32 v110, 0
    v_mov_b32 v111, 0
    s_add_u32 s70, s46, s68
    s_addc_u32 s71, s47, 0
    v_bfe_u32 v64, v1, 2, 1
    v_lshl_add_u32 v248, v64, 10, v3
    v_xor_b32 v249, 0x400, v248
    v_cmp_eq_u32 vcc, 1, v64
    v_mov_b32 v65, 0x05040100
    v_mov_b32 v66, 0x01000504
    v_cndmask_b32 v250, v65, v66, vcc
    v_add_u32 v251, 0x02020202, v250
    buffer_load_dwordx4 a[80:83], v3, s[4:7], s50 offen offset:0 nt
    buffer_load_dwordx4 a[84:87], v3, s[4:7], s50 offen offset:1024 nt
    buffer_load_dwordx4 a[88:91], v3, s[4:7], s50 offen offset:2048 nt
    buffer_load_dwordx4 a[92:95], v3, s[4:7], s50 offen offset:3072 nt
    buffer_load_dwordx4 v[192:195], v3, s[4:7], s51 offen offset:0 nt
    buffer_load_dwordx4 v[196:199], v3, s[4:7], s51 offen offset:1024 nt
    buffer_load_dwordx4 v[200:203], v3, s[4:7], s51 offen offset:2048 nt
    buffer_load_dwordx4 v[204:207], v3, s[4:7], s51 offen offset:3072 nt
    v_lshrrev_b32 v65, 4, v1
    v_and_b32 v67, 3, v1
    v_lshlrev_b32 v252, 4, v67
    v_lshl_add_u32 v252, v65, 6, v252
    v_add_u32 v252, 65536, v252
    v_lshl_add_u32 v253, v67, 2, v11
    s_lshl_b32 s60, s3, 14
    v_and_b32 v66, 15, v1
    v_lshlrev_b32 v64, 2, v65
    v_xor_b32 v64, v64, v66
    v_lshlrev_b32 v67, 10, v67
    v_bfe_u32 v68, v1, 2, 2
    buffer_load_dwordx4 a[96:99], v3, s[4:7], s80 offen offset:0 nt
    buffer_load_dwordx4 a[100:103], v3, s[4:7], s80 offen offset:1024 nt
    buffer_load_dwordx4 a[104:107], v3, s[4:7], s80 offen offset:2048 nt
    buffer_load_dwordx4 a[108:111], v3, s[4:7], s80 offen offset:3072 nt
    buffer_load_dwordx4 v[208:211], v3, s[4:7], s81 offen offset:0 nt
    buffer_load_dwordx4 v[212:215], v3, s[4:7], s81 offen offset:1024 nt
    buffer_load_dwordx4 v[216:219], v3, s[4:7], s81 offen offset:2048 nt
    buffer_load_dwordx4 v[220:223], v3, s[4:7], s81 offen offset:3072 nt
    ds_write_b32 v11, v10 offset:4
    v_lshl_add_u32 v67, v68, 8, v67
    v_add_u32 v67, s60, v67
    v_xor_b32 v66, v65, v66
    v_lshlrev_b32 v65, 8, v65
    v_add_u32 v65, s60, v65
    v_xor_b32 v68, 0, v64
    v_lshl_add_u32 v240, v68, 4, v65
    v_xor_b32 v68, 0, v66
    v_lshl_add_u32 v244, v68, 4, v67
    v_xor_b32 v68, 1, v64
    v_lshl_add_u32 v241, v68, 4, v65
    v_xor_b32 v68, 4, v66
    buffer_load_dwordx4 a[112:115], v3, s[4:7], s82 offen offset:0 nt
    buffer_load_dwordx4 a[116:119], v3, s[4:7], s82 offen offset:1024 nt
    buffer_load_dwordx4 a[120:123], v3, s[4:7], s82 offen offset:2048 nt
    buffer_load_dwordx4 a[124:127], v3, s[4:7], s82 offen offset:3072 nt
    buffer_load_dwordx4 v[224:227], v3, s[4:7], s83 offen offset:0 nt
    buffer_load_dwordx4 v[228:231], v3, s[4:7], s83 offen offset:1024 nt
    buffer_load_dwordx4 v[232:235], v3, s[4:7], s83 offen offset:2048 nt
    buffer_load_dwordx4 v[236:239], v3, s[4:7], s83 offen offset:3072 nt
    s_barrier
    v_lshl_add_u32 v245, v68, 4, v67
    v_xor_b32 v68, 2, v64
    v_lshl_add_u32 v242, v68, 4, v65
    v_xor_b32 v68, 8, v66
    v_lshl_add_u32 v246, v68, 4, v67
    v_xor_b32 v68, 3, v64
    v_lshl_add_u32 v243, v68, 4, v65
    v_xor_b32 v68, 12, v66
    v_lshl_add_u32 v247, v68, 4, v67
    s_waitcnt lgkmcnt(0)
    s_add_u32 s52, s52, 1
    s_add_u32 s53, s53, 0x9e3779b1
    s_and_b32 s44, s52, 0x3ff
    s_bfe_u32 s45, s52, 0xa000a
    s_lshr_b32 s33, s0, 6
    s_xor_b32 s33, s33, s53
    s_and_b32 s32, s33, 0x3ff
    s_bfe_u32 s33, s33, 0xa000a
    s_mov_b32 s38, 0xfffffc00
L_getq_standalone__gqa_block_cached__sampling_kernel:
    v_and_b32 v7, 3, v1
    v_lshlrev_b32 v7, 8, v7
    v_lshrrev_b32 v8, 4, v1
    v_lshl_add_u32 v7, v8, 4, v7
    v_add_u32 v7, 98304, v7
    ds_read_b32 v8, v11 offset:12
    ds_read_b128 v[16:19], v7 offset:0
    ds_read_b128 v[20:23], v7 offset:64
    ds_read_b128 v[24:27], v7 offset:128
    ds_read_b128 v[28:31], v7 offset:192
    s_waitcnt lgkmcnt(0)
    v_readfirstlane_b32 s31, v8
    s_mov_b32 s79, 6
    s_cmp_eq_u32 s3, 0
    s_cbranch_scc1 L_loop_standalone__gqa_block_cached__sampling_kernel
    s_sub_u32 s79, s61, 1
    s_add_u32 s61, s3, 6
    s_bfe_u32 s57, s61, 0x30001
    s_lshl_b32 s57, s57, 18
    s_and_b32 s58, s61, 1
    s_lshl_b32 s58, s58, 15
    s_add_u32 s57, s57, s58
    s_add_u32 s57, s57, s30
    s_and_b32 s57, s57, 0x1fffff
    s_add_u32 s48, s57, s29
    s_add_u32 s49, s48, 4096
    s_add_u32 s50, s48, 8192
    s_add_u32 s51, s48, 12288
    s_add_u32 s80, s48, 16384
    s_add_u32 s81, s48, 20480
    s_add_u32 s82, s48, 24576
    s_add_u32 s83, s48, 28672
    s_lshl_b32 s59, s79, 11
    v_add_u32 v10, s59, v252
    s_waitcnt vmcnt(60)
    v_mfma_f32_16x16x32_bf16 v[32:35], a[0:3], v[16:19], 0
    v_mfma_f32_16x16x32_bf16 v[32:35], a[4:7], v[20:23], v[32:35]
    v_mfma_f32_16x16x32_bf16 v[32:35], a[8:11], v[24:27], v[32:35]
    v_mfma_f32_16x16x32_bf16 v[32:35], a[12:15], v[28:31], v[32:35]
    s_waitcnt vmcnt(56)
    ds_write_b128 v240, v[112:115] offset:0
    ds_write_b128 v241, v[116:119] offset:1024
    ds_write_b128 v242, v[120:123] offset:2048
    ds_write_b128 v243, v[124:127] offset:3072
    ds_read_b128 v[112:115], v244 offset:0
    ds_read_b128 v[116:119], v245 offset:0
    ds_read_b128 v[120:123], v246 offset:0
    ds_read_b128 v[124:127], v247 offset:0
    s_waitcnt vmcnt(52)
    v_mfma_f32_16x16x32_bf16 v[40:43], a[16:19], v[16:19], 0
    v_mfma_f32_16x16x32_bf16 v[40:43], a[20:23], v[20:23], v[40:43]
    v_mfma_f32_16x16x32_bf16 v[40:43], a[24:27], v[24:27], v[40:43]
    v_mfma_f32_16x16x32_bf16 v[40:43], a[28:31], v[28:31], v[40:43]
    s_waitcnt vmcnt(48)
    ds_write_b128 v240, v[128:131] offset:4096
    ds_write_b128 v241, v[132:135] offset:5120
    ds_write_b128 v242, v[136:139] offset:6144
    ds_write_b128 v243, v[140:143] offset:7168
    ds_read_b128 v[128:131], v244 offset:4096
    ds_read_b128 v[132:135], v245 offset:4096
    ds_read_b128 v[136:139], v246 offset:4096
    ds_read_b128 v[140:143], v247 offset:4096
    s_waitcnt lgkmcnt(8)
    v_mfma_f32_16x16x32_bf16 v[36:39], v[112:115], v[16:19], 0
    v_mfma_f32_16x16x32_bf16 v[36:39], v[116:119], v[20:23], v[36:39]
    v_mfma_f32_16x16x32_bf16 v[36:39], v[120:123], v[24:27], v[36:39]
    v_mfma_f32_16x16x32_bf16 v[36:39], v[124:127], v[28:31], v[36:39]
    s_waitcnt vmcnt(44)
    v_mfma_f32_16x16x32_bf16 v[48:51], a[32:35], v[16:19], 0
    v_mfma_f32_16x16x32_bf16 v[48:51], a[36:39], v[20:23], v[48:51]
    v_mfma_f32_16x16x32_bf16 v[48:51], a[40:43], v[24:27], v[48:51]
    v_mfma_f32_16x16x32_bf16 v[48:51], a[44:47], v[28:31], v[48:51]
    s_waitcnt vmcnt(40)
    ds_write_b128 v240, v[144:147] offset:8192
    ds_write_b128 v241, v[148:151] offset:9216
    ds_write_b128 v242, v[152:155] offset:10240
    ds_write_b128 v243, v[156:159] offset:11264
    ds_read_b128 v[144:147], v244 offset:8192
    ds_read_b128 v[148:151], v245 offset:8192
    ds_read_b128 v[152:155], v246 offset:8192
    ds_read_b128 v[156:159], v247 offset:8192
    s_waitcnt lgkmcnt(8)
    v_mfma_f32_16x16x32_bf16 v[44:47], v[128:131], v[16:19], 0
    v_mfma_f32_16x16x32_bf16 v[44:47], v[132:135], v[20:23], v[44:47]
    v_mfma_f32_16x16x32_bf16 v[44:47], v[136:139], v[24:27], v[44:47]
    v_mfma_f32_16x16x32_bf16 v[44:47], v[140:143], v[28:31], v[44:47]
    s_waitcnt vmcnt(36)
    v_mfma_f32_16x16x32_bf16 v[56:59], a[48:51], v[16:19], 0
    v_mfma_f32_16x16x32_bf16 v[56:59], a[52:55], v[20:23], v[56:59]
    v_mfma_f32_16x16x32_bf16 v[56:59], a[56:59], v[24:27], v[56:59]
    v_mfma_f32_16x16x32_bf16 v[56:59], a[60:63], v[28:31], v[56:59]
    s_waitcnt vmcnt(32)
    ds_write_b128 v240, v[160:163] offset:12288
    ds_write_b128 v241, v[164:167] offset:13312
    ds_write_b128 v242, v[168:171] offset:14336
    ds_write_b128 v243, v[172:175] offset:15360
    ds_read_b128 v[160:163], v244 offset:12288
    ds_read_b128 v[164:167], v245 offset:12288
    ds_read_b128 v[168:171], v246 offset:12288
    ds_read_b128 v[172:175], v247 offset:12288
    s_waitcnt lgkmcnt(8)
    v_mfma_f32_16x16x32_bf16 v[52:55], v[144:147], v[16:19], 0
    v_mfma_f32_16x16x32_bf16 v[52:55], v[148:151], v[20:23], v[52:55]
    v_mfma_f32_16x16x32_bf16 v[52:55], v[152:155], v[24:27], v[52:55]
    v_mfma_f32_16x16x32_bf16 v[52:55], v[156:159], v[28:31], v[52:55]
    s_waitcnt lgkmcnt(0)
    v_mfma_f32_16x16x32_bf16 v[60:63], v[160:163], v[16:19], 0
    v_mfma_f32_16x16x32_bf16 v[60:63], v[164:167], v[20:23], v[60:63]
    v_mfma_f32_16x16x32_bf16 v[60:63], v[168:171], v[24:27], v[60:63]
    v_mfma_f32_16x16x32_bf16 v[60:63], v[172:175], v[28:31], v[60:63]
    v_max3_f32 v7, v32, v33, v34
    v_max3_f32 v8, v35, v36, v37
    v_max3_f32 v7, v7, v38, v39
    v_max3_f32 v8, v8, v40, v41
    v_max3_f32 v7, v7, v42, v43
    v_max3_f32 v8, v8, v44, v45
    v_max3_f32 v7, v7, v46, v47
    v_max3_f32 v8, v8, v48, v49
    v_max3_f32 v7, v7, v50, v51
    v_max3_f32 v8, v8, v52, v53
    v_max3_f32 v7, v7, v54, v55
    v_max3_f32 v8, v8, v56, v57
    v_max3_f32 v7, v7, v58, v59
    v_max3_f32 v8, v8, v60, v61
    v_max3_f32 v7, v7, v62, v63
    v_max_f32 v7, v7, v8
    s_mov_b32 exec_lo, 0x000f000f
    s_mov_b32 exec_hi, 0x000f000f
    ds_write_b128 v10, v[32:35] offset:0
    ds_write_b128 v10, v[36:39] offset:256
    ds_write_b128 v10, v[40:43] offset:512
    ds_write_b128 v10, v[44:47] offset:768
    ds_write_b128 v10, v[48:51] offset:1024
    ds_write_b128 v10, v[52:55] offset:1280
    ds_write_b128 v10, v[56:59] offset:1536
    ds_write_b128 v10, v[60:63] offset:1792
    ds_max_f32 v253, v7 offset:32
    s_mov_b64 exec, 1
    ds_add_u32 v11, v12 offset:8
    s_mov_b64 exec, -1
    buffer_load_dwordx4 a[0:3], v2, s[4:7], s48 offen offset:0 nt
    buffer_load_dwordx4 a[4:7], v2, s[4:7], s48 offen offset:64 nt
    buffer_load_dwordx4 a[8:11], v2, s[4:7], s48 offen offset:128 nt
    buffer_load_dwordx4 a[12:15], v2, s[4:7], s48 offen offset:192 nt
    buffer_load_dwordx4 v[112:115], v3, s[4:7], s49 offen offset:0 nt
    buffer_load_dwordx4 v[116:119], v3, s[4:7], s49 offen offset:1024 nt
    buffer_load_dwordx4 v[120:123], v3, s[4:7], s49 offen offset:2048 nt
    buffer_load_dwordx4 v[124:127], v3, s[4:7], s49 offen offset:3072 nt
    buffer_load_dwordx4 a[16:19], v2, s[4:7], s50 offen offset:0 nt
    buffer_load_dwordx4 a[20:23], v2, s[4:7], s50 offen offset:64 nt
    buffer_load_dwordx4 a[24:27], v2, s[4:7], s50 offen offset:128 nt
    buffer_load_dwordx4 a[28:31], v2, s[4:7], s50 offen offset:192 nt
    buffer_load_dwordx4 v[128:131], v3, s[4:7], s51 offen offset:0 nt
    buffer_load_dwordx4 v[132:135], v3, s[4:7], s51 offen offset:1024 nt
    buffer_load_dwordx4 v[136:139], v3, s[4:7], s51 offen offset:2048 nt
    buffer_load_dwordx4 v[140:143], v3, s[4:7], s51 offen offset:3072 nt
    buffer_load_dwordx4 a[32:35], v2, s[4:7], s80 offen offset:0 nt
    buffer_load_dwordx4 a[36:39], v2, s[4:7], s80 offen offset:64 nt
    buffer_load_dwordx4 a[40:43], v2, s[4:7], s80 offen offset:128 nt
    buffer_load_dwordx4 a[44:47], v2, s[4:7], s80 offen offset:192 nt
    buffer_load_dwordx4 v[144:147], v3, s[4:7], s81 offen offset:0 nt
    buffer_load_dwordx4 v[148:151], v3, s[4:7], s81 offen offset:1024 nt
    buffer_load_dwordx4 v[152:155], v3, s[4:7], s81 offen offset:2048 nt
    buffer_load_dwordx4 v[156:159], v3, s[4:7], s81 offen offset:3072 nt
    buffer_load_dwordx4 a[48:51], v2, s[4:7], s82 offen offset:0 nt
    buffer_load_dwordx4 a[52:55], v2, s[4:7], s82 offen offset:64 nt
    buffer_load_dwordx4 a[56:59], v2, s[4:7], s82 offen offset:128 nt
    buffer_load_dwordx4 a[60:63], v2, s[4:7], s82 offen offset:192 nt
    buffer_load_dwordx4 v[160:163], v3, s[4:7], s83 offen offset:0 nt
    buffer_load_dwordx4 v[164:167], v3, s[4:7], s83 offen offset:1024 nt
    buffer_load_dwordx4 v[168:171], v3, s[4:7], s83 offen offset:2048 nt
    buffer_load_dwordx4 v[172:175], v3, s[4:7], s83 offen offset:3072 nt
    s_add_u32 s79, s79, 1
    s_lshl_b32 s59, s79, 11
    v_add_u32 v10, s59, v252
    s_waitcnt vmcnt(60)
    ds_write_b128 v240, a[64:67] offset:0
    ds_write_b128 v241, a[68:71] offset:1024
    ds_write_b128 v242, a[72:75] offset:2048
    ds_write_b128 v243, a[76:79] offset:3072
    ds_read_b128 a[64:67], v244 offset:0
    ds_read_b128 a[68:71], v245 offset:0
    ds_read_b128 a[72:75], v246 offset:0
    ds_read_b128 a[76:79], v247 offset:0
    s_waitcnt vmcnt(56)
    ds_write_b128 v240, v[176:179] offset:4096
    ds_write_b128 v241, v[180:183] offset:5120
    ds_write_b128 v242, v[184:187] offset:6144
    ds_write_b128 v243, v[188:191] offset:7168
    ds_read_b128 v[176:179], v244 offset:4096
    ds_read_b128 v[180:183], v245 offset:4096
    ds_read_b128 v[184:187], v246 offset:4096
    ds_read_b128 v[188:191], v247 offset:4096
    s_waitcnt lgkmcnt(8)
    v_mfma_f32_16x16x32_bf16 v[32:35], a[64:67], v[16:19], 0
    v_mfma_f32_16x16x32_bf16 v[32:35], a[68:71], v[20:23], v[32:35]
    v_mfma_f32_16x16x32_bf16 v[32:35], a[72:75], v[24:27], v[32:35]
    v_mfma_f32_16x16x32_bf16 v[32:35], a[76:79], v[28:31], v[32:35]
    s_waitcnt vmcnt(52)
    ds_write_b128 v240, a[80:83] offset:8192
    ds_write_b128 v241, a[84:87] offset:9216
    ds_write_b128 v242, a[88:91] offset:10240
    ds_write_b128 v243, a[92:95] offset:11264
    ds_read_b128 a[80:83], v244 offset:8192
    ds_read_b128 a[84:87], v245 offset:8192
    ds_read_b128 a[88:91], v246 offset:8192
    ds_read_b128 a[92:95], v247 offset:8192
    s_waitcnt lgkmcnt(8)
    v_mfma_f32_16x16x32_bf16 v[36:39], v[176:179], v[16:19], 0
    v_mfma_f32_16x16x32_bf16 v[36:39], v[180:183], v[20:23], v[36:39]
    v_mfma_f32_16x16x32_bf16 v[36:39], v[184:187], v[24:27], v[36:39]
    v_mfma_f32_16x16x32_bf16 v[36:39], v[188:191], v[28:31], v[36:39]
    s_waitcnt vmcnt(48)
    ds_write_b128 v240, v[192:195] offset:12288
    ds_write_b128 v241, v[196:199] offset:13312
    ds_write_b128 v242, v[200:203] offset:14336
    ds_write_b128 v243, v[204:207] offset:15360
    ds_read_b128 v[192:195], v244 offset:12288
    ds_read_b128 v[196:199], v245 offset:12288
    ds_read_b128 v[200:203], v246 offset:12288
    ds_read_b128 v[204:207], v247 offset:12288
    s_waitcnt lgkmcnt(8)
    v_mfma_f32_16x16x32_bf16 v[40:43], a[80:83], v[16:19], 0
    v_mfma_f32_16x16x32_bf16 v[40:43], a[84:87], v[20:23], v[40:43]
    v_mfma_f32_16x16x32_bf16 v[40:43], a[88:91], v[24:27], v[40:43]
    v_mfma_f32_16x16x32_bf16 v[40:43], a[92:95], v[28:31], v[40:43]
    s_waitcnt vmcnt(44)
    ds_write_b128 v240, a[96:99] offset:0
    ds_write_b128 v241, a[100:103] offset:1024
    ds_write_b128 v242, a[104:107] offset:2048
    ds_write_b128 v243, a[108:111] offset:3072
    ds_read_b128 a[96:99], v244 offset:0
    ds_read_b128 a[100:103], v245 offset:0
    ds_read_b128 a[104:107], v246 offset:0
    ds_read_b128 a[108:111], v247 offset:0
    s_waitcnt lgkmcnt(8)
    v_mfma_f32_16x16x32_bf16 v[44:47], v[192:195], v[16:19], 0
    v_mfma_f32_16x16x32_bf16 v[44:47], v[196:199], v[20:23], v[44:47]
    v_mfma_f32_16x16x32_bf16 v[44:47], v[200:203], v[24:27], v[44:47]
    v_mfma_f32_16x16x32_bf16 v[44:47], v[204:207], v[28:31], v[44:47]
    s_waitcnt vmcnt(40)
    ds_write_b128 v240, v[208:211] offset:4096
    ds_write_b128 v241, v[212:215] offset:5120
    ds_write_b128 v242, v[216:219] offset:6144
    ds_write_b128 v243, v[220:223] offset:7168
    ds_read_b128 v[208:211], v244 offset:4096
    ds_read_b128 v[212:215], v245 offset:4096
    ds_read_b128 v[216:219], v246 offset:4096
    ds_read_b128 v[220:223], v247 offset:4096
    s_waitcnt lgkmcnt(8)
    v_mfma_f32_16x16x32_bf16 v[48:51], a[96:99], v[16:19], 0
    v_mfma_f32_16x16x32_bf16 v[48:51], a[100:103], v[20:23], v[48:51]
    v_mfma_f32_16x16x32_bf16 v[48:51], a[104:107], v[24:27], v[48:51]
    v_mfma_f32_16x16x32_bf16 v[48:51], a[108:111], v[28:31], v[48:51]
    s_waitcnt vmcnt(36)
    ds_write_b128 v240, a[112:115] offset:8192
    ds_write_b128 v241, a[116:119] offset:9216
    ds_write_b128 v242, a[120:123] offset:10240
    ds_write_b128 v243, a[124:127] offset:11264
    ds_read_b128 a[112:115], v244 offset:8192
    ds_read_b128 a[116:119], v245 offset:8192
    ds_read_b128 a[120:123], v246 offset:8192
    ds_read_b128 a[124:127], v247 offset:8192
    s_waitcnt lgkmcnt(8)
    v_mfma_f32_16x16x32_bf16 v[52:55], v[208:211], v[16:19], 0
    v_mfma_f32_16x16x32_bf16 v[52:55], v[212:215], v[20:23], v[52:55]
    v_mfma_f32_16x16x32_bf16 v[52:55], v[216:219], v[24:27], v[52:55]
    v_mfma_f32_16x16x32_bf16 v[52:55], v[220:223], v[28:31], v[52:55]
    s_waitcnt vmcnt(32)
    ds_write_b128 v240, v[224:227] offset:12288
    ds_write_b128 v241, v[228:231] offset:13312
    ds_write_b128 v242, v[232:235] offset:14336
    ds_write_b128 v243, v[236:239] offset:15360
    ds_read_b128 v[224:227], v244 offset:12288
    ds_read_b128 v[228:231], v245 offset:12288
    ds_read_b128 v[232:235], v246 offset:12288
    ds_read_b128 v[236:239], v247 offset:12288
    s_waitcnt lgkmcnt(8)
    v_mfma_f32_16x16x32_bf16 v[56:59], a[112:115], v[16:19], 0
    v_mfma_f32_16x16x32_bf16 v[56:59], a[116:119], v[20:23], v[56:59]
    v_mfma_f32_16x16x32_bf16 v[56:59], a[120:123], v[24:27], v[56:59]
    v_mfma_f32_16x16x32_bf16 v[56:59], a[124:127], v[28:31], v[56:59]
    s_waitcnt lgkmcnt(0)
    v_mfma_f32_16x16x32_bf16 v[60:63], v[224:227], v[16:19], 0
    v_mfma_f32_16x16x32_bf16 v[60:63], v[228:231], v[20:23], v[60:63]
    v_mfma_f32_16x16x32_bf16 v[60:63], v[232:235], v[24:27], v[60:63]
    v_mfma_f32_16x16x32_bf16 v[60:63], v[236:239], v[28:31], v[60:63]
    v_max3_f32 v7, v32, v33, v34
    v_max3_f32 v8, v35, v36, v37
    v_max3_f32 v7, v7, v38, v39
    v_max3_f32 v8, v8, v40, v41
    v_max3_f32 v7, v7, v42, v43
    v_max3_f32 v8, v8, v44, v45
    v_max3_f32 v7, v7, v46, v47
    v_max3_f32 v8, v8, v48, v49
    v_max3_f32 v7, v7, v50, v51
    v_max3_f32 v8, v8, v52, v53
    v_max3_f32 v7, v7, v54, v55
    v_max3_f32 v8, v8, v56, v57
    v_max3_f32 v7, v7, v58, v59
    v_max3_f32 v8, v8, v60, v61
    v_max3_f32 v7, v7, v62, v63
    v_max_f32 v7, v7, v8
    s_mov_b32 exec_lo, 0x000f000f
    s_mov_b32 exec_hi, 0x000f000f
    ds_write_b128 v10, v[32:35] offset:0
    ds_write_b128 v10, v[36:39] offset:256
    ds_write_b128 v10, v[40:43] offset:512
    ds_write_b128 v10, v[44:47] offset:768
    ds_write_b128 v10, v[48:51] offset:1024
    ds_write_b128 v10, v[52:55] offset:1280
    ds_write_b128 v10, v[56:59] offset:1536
    ds_write_b128 v10, v[60:63] offset:1792
    ds_max_f32 v253, v7 offset:32
    s_mov_b64 exec, 1
    ds_add_u32 v11, v12 offset:8
    s_mov_b64 exec, -1
    s_mov_b32 s79, s61
L_loop_standalone__gqa_block_cached__sampling_kernel:
    s_mov_b64 exec, 1
    ds_add_rtn_u32 v13, v11, v12
    s_mov_b64 exec, -1
    s_waitcnt lgkmcnt(0)
    v_readfirstlane_b32 s61, v13
    s_cmp_ge_u32 s61, 32
    s_cbranch_scc1 L_pred_standalone__gqa_block_cached__sampling_kernel
    s_mov_b32 s77, 1
    s_cmp_lg_u32 s61, 26
    s_cbranch_scc1 L_nb_standalone__gqa_block_cached__sampling_kernel
    s_atomic_add s77, s[70:71], 0x30500 glc
L_nb_standalone__gqa_block_cached__sampling_kernel:
    s_bfe_u32 s57, s61, 0x30001
    s_lshl_b32 s57, s57, 18
    s_and_b32 s58, s61, 1
    s_lshl_b32 s58, s58, 15
    s_add_u32 s57, s57, s58
    s_add_u32 s57, s57, s30
    s_and_b32 s57, s57, 0x1fffff
    s_add_u32 s48, s57, s29
    s_add_u32 s49, s48, 4096
    s_add_u32 s50, s48, 8192
    s_add_u32 s51, s48, 12288
    s_add_u32 s80, s48, 16384
    s_add_u32 s81, s48, 20480
    s_add_u32 s82, s48, 24576
    s_add_u32 s83, s48, 28672
    s_cmp_ge_u32 s79, 16
    s_cbranch_scc1 L_pv_standalone__gqa_block_cached__sampling_kernel
    s_lshl_b32 s59, s79, 11
    v_add_u32 v10, s59, v252
    s_waitcnt vmcnt(28)
    v_mfma_f32_16x16x32_bf16 v[32:35], a[0:3], v[16:19], 0
    v_mfma_f32_16x16x32_bf16 v[32:35], a[4:7], v[20:23], v[32:35]
    v_mfma_f32_16x16x32_bf16 v[32:35], a[8:11], v[24:27], v[32:35]
    v_mfma_f32_16x16x32_bf16 v[32:35], a[12:15], v[28:31], v[32:35]
    s_waitcnt vmcnt(24)
    ds_write_b128 v240, v[112:115] offset:0
    ds_write_b128 v241, v[116:119] offset:1024
    ds_write_b128 v242, v[120:123] offset:2048
    ds_write_b128 v243, v[124:127] offset:3072
    ds_read_b128 v[112:115], v244 offset:0
    ds_read_b128 v[116:119], v245 offset:0
    ds_read_b128 v[120:123], v246 offset:0
    ds_read_b128 v[124:127], v247 offset:0
    s_waitcnt vmcnt(20)
    v_mfma_f32_16x16x32_bf16 v[40:43], a[16:19], v[16:19], 0
    v_mfma_f32_16x16x32_bf16 v[40:43], a[20:23], v[20:23], v[40:43]
    v_mfma_f32_16x16x32_bf16 v[40:43], a[24:27], v[24:27], v[40:43]
    v_mfma_f32_16x16x32_bf16 v[40:43], a[28:31], v[28:31], v[40:43]
    s_waitcnt vmcnt(16)
    ds_write_b128 v240, v[128:131] offset:4096
    ds_write_b128 v241, v[132:135] offset:5120
    ds_write_b128 v242, v[136:139] offset:6144
    ds_write_b128 v243, v[140:143] offset:7168
    ds_read_b128 v[128:131], v244 offset:4096
    ds_read_b128 v[132:135], v245 offset:4096
    ds_read_b128 v[136:139], v246 offset:4096
    ds_read_b128 v[140:143], v247 offset:4096
    s_waitcnt lgkmcnt(8)
    v_mfma_f32_16x16x32_bf16 v[36:39], v[112:115], v[16:19], 0
    v_mfma_f32_16x16x32_bf16 v[36:39], v[116:119], v[20:23], v[36:39]
    v_mfma_f32_16x16x32_bf16 v[36:39], v[120:123], v[24:27], v[36:39]
    v_mfma_f32_16x16x32_bf16 v[36:39], v[124:127], v[28:31], v[36:39]
    s_waitcnt vmcnt(12)
    v_mfma_f32_16x16x32_bf16 v[48:51], a[32:35], v[16:19], 0
    v_mfma_f32_16x16x32_bf16 v[48:51], a[36:39], v[20:23], v[48:51]
    v_mfma_f32_16x16x32_bf16 v[48:51], a[40:43], v[24:27], v[48:51]
    v_mfma_f32_16x16x32_bf16 v[48:51], a[44:47], v[28:31], v[48:51]
    s_waitcnt vmcnt(8)
    ds_write_b128 v240, v[144:147] offset:8192
    ds_write_b128 v241, v[148:151] offset:9216
    ds_write_b128 v242, v[152:155] offset:10240
    ds_write_b128 v243, v[156:159] offset:11264
    ds_read_b128 v[144:147], v244 offset:8192
    ds_read_b128 v[148:151], v245 offset:8192
    ds_read_b128 v[152:155], v246 offset:8192
    ds_read_b128 v[156:159], v247 offset:8192
    s_waitcnt lgkmcnt(8)
    v_mfma_f32_16x16x32_bf16 v[44:47], v[128:131], v[16:19], 0
    v_mfma_f32_16x16x32_bf16 v[44:47], v[132:135], v[20:23], v[44:47]
    v_mfma_f32_16x16x32_bf16 v[44:47], v[136:139], v[24:27], v[44:47]
    v_mfma_f32_16x16x32_bf16 v[44:47], v[140:143], v[28:31], v[44:47]
    s_waitcnt vmcnt(4)
    v_mfma_f32_16x16x32_bf16 v[56:59], a[48:51], v[16:19], 0
    v_mfma_f32_16x16x32_bf16 v[56:59], a[52:55], v[20:23], v[56:59]
    v_mfma_f32_16x16x32_bf16 v[56:59], a[56:59], v[24:27], v[56:59]
    v_mfma_f32_16x16x32_bf16 v[56:59], a[60:63], v[28:31], v[56:59]
    s_waitcnt vmcnt(0)
    ds_write_b128 v240, v[160:163] offset:12288
    ds_write_b128 v241, v[164:167] offset:13312
    ds_write_b128 v242, v[168:171] offset:14336
    ds_write_b128 v243, v[172:175] offset:15360
    ds_read_b128 v[160:163], v244 offset:12288
    ds_read_b128 v[164:167], v245 offset:12288
    ds_read_b128 v[168:171], v246 offset:12288
    ds_read_b128 v[172:175], v247 offset:12288
    s_waitcnt lgkmcnt(8)
    v_mfma_f32_16x16x32_bf16 v[52:55], v[144:147], v[16:19], 0
    v_mfma_f32_16x16x32_bf16 v[52:55], v[148:151], v[20:23], v[52:55]
    v_mfma_f32_16x16x32_bf16 v[52:55], v[152:155], v[24:27], v[52:55]
    v_mfma_f32_16x16x32_bf16 v[52:55], v[156:159], v[28:31], v[52:55]
    s_waitcnt lgkmcnt(0)
    v_mfma_f32_16x16x32_bf16 v[60:63], v[160:163], v[16:19], 0
    v_mfma_f32_16x16x32_bf16 v[60:63], v[164:167], v[20:23], v[60:63]
    v_mfma_f32_16x16x32_bf16 v[60:63], v[168:171], v[24:27], v[60:63]
    v_mfma_f32_16x16x32_bf16 v[60:63], v[172:175], v[28:31], v[60:63]
    v_max3_f32 v7, v32, v33, v34
    v_max3_f32 v8, v35, v36, v37
    v_max3_f32 v7, v7, v38, v39
    v_max3_f32 v8, v8, v40, v41
    v_max3_f32 v7, v7, v42, v43
    v_max3_f32 v8, v8, v44, v45
    v_max3_f32 v7, v7, v46, v47
    v_max3_f32 v8, v8, v48, v49
    v_max3_f32 v7, v7, v50, v51
    v_max3_f32 v8, v8, v52, v53
    v_max3_f32 v7, v7, v54, v55
    v_max3_f32 v8, v8, v56, v57
    v_max3_f32 v7, v7, v58, v59
    v_max3_f32 v8, v8, v60, v61
    v_max3_f32 v7, v7, v62, v63
    v_max_f32 v7, v7, v8
    s_mov_b32 exec_lo, 0x000f000f
    s_mov_b32 exec_hi, 0x000f000f
    ds_write_b128 v10, v[32:35] offset:0
    ds_write_b128 v10, v[36:39] offset:256
    ds_write_b128 v10, v[40:43] offset:512
    ds_write_b128 v10, v[44:47] offset:768
    ds_write_b128 v10, v[48:51] offset:1024
    ds_write_b128 v10, v[52:55] offset:1280
    ds_write_b128 v10, v[56:59] offset:1536
    ds_write_b128 v10, v[60:63] offset:1792
    ds_max_f32 v253, v7 offset:32
    s_mov_b64 exec, 1
    ds_add_u32 v11, v12 offset:8
    s_mov_b64 exec, -1
    s_mov_b32 s79, s61
    s_cmp_ge_u32 s61, 16
    s_cbranch_scc1 L_bv_standalone__gqa_block_cached__sampling_kernel
    buffer_load_dwordx4 a[0:3], v2, s[4:7], s48 offen offset:0 nt
    buffer_load_dwordx4 a[4:7], v2, s[4:7], s48 offen offset:64 nt
    buffer_load_dwordx4 a[8:11], v2, s[4:7], s48 offen offset:128 nt
    buffer_load_dwordx4 a[12:15], v2, s[4:7], s48 offen offset:192 nt
    buffer_load_dwordx4 v[112:115], v3, s[4:7], s49 offen offset:0 nt
    buffer_load_dwordx4 v[116:119], v3, s[4:7], s49 offen offset:1024 nt
    buffer_load_dwordx4 v[120:123], v3, s[4:7], s49 offen offset:2048 nt
    buffer_load_dwordx4 v[124:127], v3, s[4:7], s49 offen offset:3072 nt
    buffer_load_dwordx4 a[16:19], v2, s[4:7], s50 offen offset:0 nt
    buffer_load_dwordx4 a[20:23], v2, s[4:7], s50 offen offset:64 nt
    buffer_load_dwordx4 a[24:27], v2, s[4:7], s50 offen offset:128 nt
    buffer_load_dwordx4 a[28:31], v2, s[4:7], s50 offen offset:192 nt
    buffer_load_dwordx4 v[128:131], v3, s[4:7], s51 offen offset:0 nt
    buffer_load_dwordx4 v[132:135], v3, s[4:7], s51 offen offset:1024 nt
    buffer_load_dwordx4 v[136:139], v3, s[4:7], s51 offen offset:2048 nt
    buffer_load_dwordx4 v[140:143], v3, s[4:7], s51 offen offset:3072 nt
    buffer_load_dwordx4 a[32:35], v2, s[4:7], s80 offen offset:0 nt
    buffer_load_dwordx4 a[36:39], v2, s[4:7], s80 offen offset:64 nt
    buffer_load_dwordx4 a[40:43], v2, s[4:7], s80 offen offset:128 nt
    buffer_load_dwordx4 a[44:47], v2, s[4:7], s80 offen offset:192 nt
    buffer_load_dwordx4 v[144:147], v3, s[4:7], s81 offen offset:0 nt
    buffer_load_dwordx4 v[148:151], v3, s[4:7], s81 offen offset:1024 nt
    buffer_load_dwordx4 v[152:155], v3, s[4:7], s81 offen offset:2048 nt
    buffer_load_dwordx4 v[156:159], v3, s[4:7], s81 offen offset:3072 nt
    buffer_load_dwordx4 a[48:51], v2, s[4:7], s82 offen offset:0 nt
    buffer_load_dwordx4 a[52:55], v2, s[4:7], s82 offen offset:64 nt
    buffer_load_dwordx4 a[56:59], v2, s[4:7], s82 offen offset:128 nt
    buffer_load_dwordx4 a[60:63], v2, s[4:7], s82 offen offset:192 nt
    buffer_load_dwordx4 v[160:163], v3, s[4:7], s83 offen offset:0 nt
    buffer_load_dwordx4 v[164:167], v3, s[4:7], s83 offen offset:1024 nt
    buffer_load_dwordx4 v[168:171], v3, s[4:7], s83 offen offset:2048 nt
    buffer_load_dwordx4 v[172:175], v3, s[4:7], s83 offen offset:3072 nt
    s_branch L_loop_standalone__gqa_block_cached__sampling_kernel
L_pv_standalone__gqa_block_cached__sampling_kernel:
    s_cmp_lg_u32 s69, 0
    s_cbranch_scc1 L_hm1_standalone__gqa_block_cached__sampling_kernel
    s_mov_b32 s60, 2097152
L_kd1_standalone__gqa_block_cached__sampling_kernel:
    ds_read_b32 v7, v11 offset:8
    s_sub_u32 s60, s60, 1
    s_waitcnt lgkmcnt(0)
    v_readfirstlane_b32 s59, v7
    s_cmp_ge_u32 s59, 16
    s_cbranch_scc1 L_kd1ok_standalone__gqa_block_cached__sampling_kernel
    s_sleep 1
    s_cmp_lg_u32 s60, 0
    s_cbranch_scc1 L_kd1_standalone__gqa_block_cached__sampling_kernel
L_kd1ok_standalone__gqa_block_cached__sampling_kernel:
    ds_read_b32 v4, v253 offset:32
    s_mov_b32 s69, 1
    s_waitcnt lgkmcnt(0)
    v_mul_f32 v5, s54, v4
L_hm1_standalone__gqa_block_cached__sampling_kernel:
    s_and_b32 s59, s79, 15
    s_lshl_b32 s59, s59, 11
    v_add_u32 v10, s59, v252
    ds_read_b128 v[32:35], v10 offset:0
    ds_read_b128 v[36:39], v10 offset:256
    ds_read_b128 v[40:43], v10 offset:512
    ds_read_b128 v[44:47], v10 offset:768
    ds_read_b128 v[48:51], v10 offset:1024
    ds_read_b128 v[52:55], v10 offset:1280
    ds_read_b128 v[56:59], v10 offset:1536
    ds_read_b128 v[60:63], v10 offset:1792
    s_waitcnt lgkmcnt(4)
    v_fma_f32 v32, v32, s54, -v5
    v_fma_f32 v33, v33, s54, -v5
    v_fma_f32 v34, v34, s54, -v5
    v_fma_f32 v35, v35, s54, -v5
    v_fma_f32 v36, v36, s54, -v5
    v_fma_f32 v37, v37, s54, -v5
    v_fma_f32 v38, v38, s54, -v5
    v_fma_f32 v39, v39, s54, -v5
    v_fma_f32 v40, v40, s54, -v5
    v_fma_f32 v41, v41, s54, -v5
    v_fma_f32 v42, v42, s54, -v5
    v_fma_f32 v43, v43, s54, -v5
    v_fma_f32 v44, v44, s54, -v5
    v_fma_f32 v45, v45, s54, -v5
    v_fma_f32 v46, v46, s54, -v5
    v_fma_f32 v47, v47, s54, -v5
    v_exp_f32 v32, v32
    v_exp_f32 v33, v33
    v_exp_f32 v34, v34
    v_exp_f32 v35, v35
    v_exp_f32 v36, v36
    v_exp_f32 v37, v37
    v_exp_f32 v38, v38
    v_exp_f32 v39, v39
    v_exp_f32 v40, v40
    v_exp_f32 v41, v41
    v_exp_f32 v42, v42
    v_exp_f32 v43, v43
    v_exp_f32 v44, v44
    v_exp_f32 v45, v45
    v_exp_f32 v46, v46
    v_exp_f32 v47, v47
    s_nop 0
    v_cvt_pk_bf16_f32 v16, v32, v33
    v_cvt_pk_bf16_f32 v17, v34, v35
    v_cvt_pk_bf16_f32 v18, v36, v37
    v_cvt_pk_bf16_f32 v19, v38, v39
    v_cvt_pk_bf16_f32 v20, v40, v41
    v_cvt_pk_bf16_f32 v21, v42, v43
    v_cvt_pk_bf16_f32 v22, v44, v45
    v_cvt_pk_bf16_f32 v23, v46, v47
    s_waitcnt lgkmcnt(0)
    v_fma_f32 v48, v48, s54, -v5
    v_fma_f32 v49, v49, s54, -v5
    v_fma_f32 v50, v50, s54, -v5
    v_fma_f32 v51, v51, s54, -v5
    v_fma_f32 v52, v52, s54, -v5
    v_fma_f32 v53, v53, s54, -v5
    v_fma_f32 v54, v54, s54, -v5
    v_fma_f32 v55, v55, s54, -v5
    v_fma_f32 v56, v56, s54, -v5
    v_fma_f32 v57, v57, s54, -v5
    v_fma_f32 v58, v58, s54, -v5
    v_fma_f32 v59, v59, s54, -v5
    v_fma_f32 v60, v60, s54, -v5
    v_fma_f32 v61, v61, s54, -v5
    v_fma_f32 v62, v62, s54, -v5
    v_fma_f32 v63, v63, s54, -v5
    v_exp_f32 v48, v48
    v_exp_f32 v49, v49
    v_exp_f32 v50, v50
    v_exp_f32 v51, v51
    v_exp_f32 v52, v52
    v_exp_f32 v53, v53
    v_exp_f32 v54, v54
    v_exp_f32 v55, v55
    v_exp_f32 v56, v56
    v_exp_f32 v57, v57
    v_exp_f32 v58, v58
    v_exp_f32 v59, v59
    v_exp_f32 v60, v60
    v_exp_f32 v61, v61
    v_exp_f32 v62, v62
    v_exp_f32 v63, v63
    s_nop 0
    v_cvt_pk_bf16_f32 v24, v48, v49
    v_cvt_pk_bf16_f32 v25, v50, v51
    v_cvt_pk_bf16_f32 v26, v52, v53
    v_cvt_pk_bf16_f32 v27, v54, v55
    v_cvt_pk_bf16_f32 v28, v56, v57
    v_cvt_pk_bf16_f32 v29, v58, v59
    v_cvt_pk_bf16_f32 v30, v60, v61
    v_cvt_pk_bf16_f32 v31, v62, v63
    s_waitcnt vmcnt(24)
    v_perm_b32 v64, v116, v112, v250
    v_perm_b32 v65, v124, v120, v250
    v_perm_b32 v66, v132, v128, s55
    v_perm_b32 v67, v140, v136, s55
    v_perm_b32 v68, v116, v112, v251
    v_perm_b32 v69, v124, v120, v251
    v_perm_b32 v70, v132, v128, s56
    v_perm_b32 v71, v140, v136, s56
    v_mfma_f32_16x16x32_bf16 v[80:83], v[64:67], v[16:19], v[80:83]
    v_perm_b32 v72, v117, v113, v250
    v_perm_b32 v73, v125, v121, v250
    v_perm_b32 v74, v133, v129, s55
    v_perm_b32 v75, v141, v137, s55
    v_mfma_f32_16x16x32_bf16 v[84:87], v[68:71], v[16:19], v[84:87]
    v_perm_b32 v76, v117, v113, v251
    v_perm_b32 v77, v125, v121, v251
    v_perm_b32 v78, v133, v129, s56
    v_perm_b32 v79, v141, v137, s56
    v_mfma_f32_16x16x32_bf16 v[88:91], v[72:75], v[16:19], v[88:91]
    v_perm_b32 v64, v118, v114, v250
    v_perm_b32 v65, v126, v122, v250
    v_perm_b32 v66, v134, v130, s55
    v_perm_b32 v67, v142, v138, s55
    v_mfma_f32_16x16x32_bf16 v[92:95], v[76:79], v[16:19], v[92:95]
    v_perm_b32 v68, v118, v114, v251
    v_perm_b32 v69, v126, v122, v251
    v_perm_b32 v70, v134, v130, s56
    v_perm_b32 v71, v142, v138, s56
    v_mfma_f32_16x16x32_bf16 v[96:99], v[64:67], v[16:19], v[96:99]
    v_perm_b32 v72, v119, v115, v250
    v_perm_b32 v73, v127, v123, v250
    v_perm_b32 v74, v135, v131, s55
    v_perm_b32 v75, v143, v139, s55
    v_mfma_f32_16x16x32_bf16 v[100:103], v[68:71], v[16:19], v[100:103]
    v_perm_b32 v76, v119, v115, v251
    v_perm_b32 v77, v127, v123, v251
    v_perm_b32 v78, v135, v131, s56
    v_perm_b32 v79, v143, v139, s56
    v_mfma_f32_16x16x32_bf16 v[104:107], v[72:75], v[16:19], v[104:107]
    s_nop 0
    v_mfma_f32_16x16x32_bf16 v[108:111], v[76:79], v[16:19], v[108:111]
    s_waitcnt vmcnt(16)
    v_perm_b32 v64, v148, v144, v250
    v_perm_b32 v65, v156, v152, v250
    v_perm_b32 v66, v164, v160, s55
    v_perm_b32 v67, v172, v168, s55
    v_perm_b32 v68, v148, v144, v251
    v_perm_b32 v69, v156, v152, v251
    v_perm_b32 v70, v164, v160, s56
    v_perm_b32 v71, v172, v168, s56
    v_mfma_f32_16x16x32_bf16 v[80:83], v[64:67], v[20:23], v[80:83]
    v_perm_b32 v72, v149, v145, v250
    v_perm_b32 v73, v157, v153, v250
    v_perm_b32 v74, v165, v161, s55
    v_perm_b32 v75, v173, v169, s55
    v_mfma_f32_16x16x32_bf16 v[84:87], v[68:71], v[20:23], v[84:87]
    v_perm_b32 v76, v149, v145, v251
    v_perm_b32 v77, v157, v153, v251
    v_perm_b32 v78, v165, v161, s56
    v_perm_b32 v79, v173, v169, s56
    v_mfma_f32_16x16x32_bf16 v[88:91], v[72:75], v[20:23], v[88:91]
    v_perm_b32 v64, v150, v146, v250
    v_perm_b32 v65, v158, v154, v250
    v_perm_b32 v66, v166, v162, s55
    v_perm_b32 v67, v174, v170, s55
    v_mfma_f32_16x16x32_bf16 v[92:95], v[76:79], v[20:23], v[92:95]
    v_perm_b32 v68, v150, v146, v251
    v_perm_b32 v69, v158, v154, v251
    v_perm_b32 v70, v166, v162, s56
    v_perm_b32 v71, v174, v170, s56
    v_mfma_f32_16x16x32_bf16 v[96:99], v[64:67], v[20:23], v[96:99]
    v_perm_b32 v72, v151, v147, v250
    v_perm_b32 v73, v159, v155, v250
    v_perm_b32 v74, v167, v163, s55
    v_perm_b32 v75, v175, v171, s55
    v_mfma_f32_16x16x32_bf16 v[100:103], v[68:71], v[20:23], v[100:103]
    v_perm_b32 v76, v151, v147, v251
    v_perm_b32 v77, v159, v155, v251
    v_perm_b32 v78, v167, v163, s56
    v_perm_b32 v79, v175, v171, s56
    v_mfma_f32_16x16x32_bf16 v[104:107], v[72:75], v[20:23], v[104:107]
    s_nop 0
    v_mfma_f32_16x16x32_bf16 v[108:111], v[76:79], v[20:23], v[108:111]
    v_add_f32 v7, v32, v33
    v_add_f32 v8, v34, v35
    v_add_f32 v7, v7, v36
    v_add_f32 v8, v8, v37
    v_add_f32 v7, v7, v38
    v_add_f32 v8, v8, v39
    v_add_f32 v7, v7, v40
    v_add_f32 v8, v8, v41
    v_add_f32 v7, v7, v42
    v_add_f32 v8, v8, v43
    v_add_f32 v7, v7, v44
    v_add_f32 v8, v8, v45
    v_add_f32 v7, v7, v46
    v_add_f32 v8, v8, v47
    v_add_f32 v7, v7, v48
    v_add_f32 v8, v8, v49
    v_add_f32 v7, v7, v50
    v_add_f32 v8, v8, v51
    v_add_f32 v7, v7, v52
    v_add_f32 v8, v8, v53
    v_add_f32 v7, v7, v54
    v_add_f32 v8, v8, v55
    v_add_f32 v7, v7, v56
    v_add_f32 v8, v8, v57
    v_add_f32 v7, v7, v58
    v_add_f32 v8, v8, v59
    v_add_f32 v7, v7, v60
    v_add_f32 v8, v8, v61
    v_add_f32 v7, v7, v62
    v_add_f32 v8, v8, v63
    v_add_f32 v7, v7, v8
    v_add_f32 v6, v6, v7
    s_waitcnt vmcnt(8)
    v_perm_b32 v64, v180, v176, v250
    v_perm_b32 v65, v188, v184, v250
    v_perm_b32 v66, v196, v192, s55
    v_perm_b32 v67, v204, v200, s55
    v_perm_b32 v68, v180, v176, v251
    v_perm_b32 v69, v188, v184, v251
    v_perm_b32 v70, v196, v192, s56
    v_perm_b32 v71, v204, v200, s56
    v_mfma_f32_16x16x32_bf16 v[80:83], v[64:67], v[24:27], v[80:83]
    v_perm_b32 v72, v181, v177, v250
    v_perm_b32 v73, v189, v185, v250
    v_perm_b32 v74, v197, v193, s55
    v_perm_b32 v75, v205, v201, s55
    v_mfma_f32_16x16x32_bf16 v[84:87], v[68:71], v[24:27], v[84:87]
    v_perm_b32 v76, v181, v177, v251
    v_perm_b32 v77, v189, v185, v251
    v_perm_b32 v78, v197, v193, s56
    v_perm_b32 v79, v205, v201, s56
    v_mfma_f32_16x16x32_bf16 v[88:91], v[72:75], v[24:27], v[88:91]
    v_perm_b32 v64, v182, v178, v250
    v_perm_b32 v65, v190, v186, v250
    v_perm_b32 v66, v198, v194, s55
    v_perm_b32 v67, v206, v202, s55
    v_mfma_f32_16x16x32_bf16 v[92:95], v[76:79], v[24:27], v[92:95]
    v_perm_b32 v68, v182, v178, v251
    v_perm_b32 v69, v190, v186, v251
    v_perm_b32 v70, v198, v194, s56
    v_perm_b32 v71, v206, v202, s56
    v_mfma_f32_16x16x32_bf16 v[96:99], v[64:67], v[24:27], v[96:99]
    v_perm_b32 v72, v183, v179, v250
    v_perm_b32 v73, v191, v187, v250
    v_perm_b32 v74, v199, v195, s55
    v_perm_b32 v75, v207, v203, s55
    v_mfma_f32_16x16x32_bf16 v[100:103], v[68:71], v[24:27], v[100:103]
    v_perm_b32 v76, v183, v179, v251
    v_perm_b32 v77, v191, v187, v251
    v_perm_b32 v78, v199, v195, s56
    v_perm_b32 v79, v207, v203, s56
    v_mfma_f32_16x16x32_bf16 v[104:107], v[72:75], v[24:27], v[104:107]
    s_nop 0
    v_mfma_f32_16x16x32_bf16 v[108:111], v[76:79], v[24:27], v[108:111]
    s_waitcnt vmcnt(0)
    v_perm_b32 v64, v212, v208, v250
    v_perm_b32 v65, v220, v216, v250
    v_perm_b32 v66, v228, v224, s55
    v_perm_b32 v67, v236, v232, s55
    v_perm_b32 v68, v212, v208, v251
    v_perm_b32 v69, v220, v216, v251
    v_perm_b32 v70, v228, v224, s56
    v_perm_b32 v71, v236, v232, s56
    v_mfma_f32_16x16x32_bf16 v[80:83], v[64:67], v[28:31], v[80:83]
    v_perm_b32 v72, v213, v209, v250
    v_perm_b32 v73, v221, v217, v250
    v_perm_b32 v74, v229, v225, s55
    v_perm_b32 v75, v237, v233, s55
    v_mfma_f32_16x16x32_bf16 v[84:87], v[68:71], v[28:31], v[84:87]
    v_perm_b32 v76, v213, v209, v251
    v_perm_b32 v77, v221, v217, v251
    v_perm_b32 v78, v229, v225, s56
    v_perm_b32 v79, v237, v233, s56
    v_mfma_f32_16x16x32_bf16 v[88:91], v[72:75], v[28:31], v[88:91]
    v_perm_b32 v64, v214, v210, v250
    v_perm_b32 v65, v222, v218, v250
    v_perm_b32 v66, v230, v226, s55
    v_perm_b32 v67, v238, v234, s55
    v_mfma_f32_16x16x32_bf16 v[92:95], v[76:79], v[28:31], v[92:95]
    v_perm_b32 v68, v214, v210, v251
    v_perm_b32 v69, v222, v218, v251
    v_perm_b32 v70, v230, v226, s56
    v_perm_b32 v71, v238, v234, s56
    v_mfma_f32_16x16x32_bf16 v[96:99], v[64:67], v[28:31], v[96:99]
    v_perm_b32 v72, v215, v211, v250
    v_perm_b32 v73, v223, v219, v250
    v_perm_b32 v74, v231, v227, s55
    v_perm_b32 v75, v239, v235, s55
    v_mfma_f32_16x16x32_bf16 v[100:103], v[68:71], v[28:31], v[100:103]
    v_perm_b32 v76, v215, v211, v251
    v_perm_b32 v77, v223, v219, v251
    v_perm_b32 v78, v231, v227, s56
    v_perm_b32 v79, v239, v235, s56
    v_mfma_f32_16x16x32_bf16 v[104:107], v[72:75], v[28:31], v[104:107]
    s_nop 0
    v_mfma_f32_16x16x32_bf16 v[108:111], v[76:79], v[28:31], v[108:111]
    s_mov_b32 s79, s61
L_bv_standalone__gqa_block_cached__sampling_kernel:
    s_cmp_lg_u32 s61, 26
    s_cbranch_scc1 L_nt_standalone__gqa_block_cached__sampling_kernel
    s_waitcnt lgkmcnt(0)
    s_add_u32 s77, s77, 2
    v_mov_b32 v7, s77
    ds_write_b32 v11, v7 offset:28
L_nt_standalone__gqa_block_cached__sampling_kernel:
    s_cmp_lt_u32 s61, 28
    s_cbranch_scc1 L_nf_standalone__gqa_block_cached__sampling_kernel
    ds_read_b32 v7, v11 offset:28
    s_waitcnt lgkmcnt(0)
    v_readfirstlane_b32 s59, v7
    s_cmp_le_u32 s59, 20
    s_cbranch_scc1 L_nf_standalone__gqa_block_cached__sampling_kernel
    v_mov_b32 v248, v3
    v_add_u32 v249, 0x400, v3
    v_mov_b32 v250, s55
    v_mov_b32 v251, s56
L_nf_standalone__gqa_block_cached__sampling_kernel:
    buffer_load_dwordx4 v[112:115], v248, s[8:11], s48 offen offset:0 nt
    buffer_load_dwordx4 v[116:119], v249, s[8:11], s48 offen offset:0 nt
    buffer_load_dwordx4 v[120:123], v248, s[8:11], s48 offen offset:2048 nt
    buffer_load_dwordx4 v[124:127], v249, s[8:11], s48 offen offset:2048 nt
    buffer_load_dwordx4 v[128:131], v3, s[8:11], s49 offen offset:0 nt
    buffer_load_dwordx4 v[132:135], v3, s[8:11], s49 offen offset:1024 nt
    buffer_load_dwordx4 v[136:139], v3, s[8:11], s49 offen offset:2048 nt
    buffer_load_dwordx4 v[140:143], v3, s[8:11], s49 offen offset:3072 nt
    buffer_load_dwordx4 v[144:147], v248, s[8:11], s50 offen offset:0 nt
    buffer_load_dwordx4 v[148:151], v249, s[8:11], s50 offen offset:0 nt
    buffer_load_dwordx4 v[152:155], v248, s[8:11], s50 offen offset:2048 nt
    buffer_load_dwordx4 v[156:159], v249, s[8:11], s50 offen offset:2048 nt
    buffer_load_dwordx4 v[160:163], v3, s[8:11], s51 offen offset:0 nt
    buffer_load_dwordx4 v[164:167], v3, s[8:11], s51 offen offset:1024 nt
    buffer_load_dwordx4 v[168:171], v3, s[8:11], s51 offen offset:2048 nt
    buffer_load_dwordx4 v[172:175], v3, s[8:11], s51 offen offset:3072 nt
    buffer_load_dwordx4 v[176:179], v248, s[8:11], s80 offen offset:0 nt
    buffer_load_dwordx4 v[180:183], v249, s[8:11], s80 offen offset:0 nt
    buffer_load_dwordx4 v[184:187], v248, s[8:11], s80 offen offset:2048 nt
    buffer_load_dwordx4 v[188:191], v249, s[8:11], s80 offen offset:2048 nt
    buffer_load_dwordx4 v[192:195], v3, s[8:11], s81 offen offset:0 nt
    buffer_load_dwordx4 v[196:199], v3, s[8:11], s81 offen offset:1024 nt
    buffer_load_dwordx4 v[200:203], v3, s[8:11], s81 offen offset:2048 nt
    buffer_load_dwordx4 v[204:207], v3, s[8:11], s81 offen offset:3072 nt
    buffer_load_dwordx4 v[208:211], v248, s[8:11], s82 offen offset:0 nt
    buffer_load_dwordx4 v[212:215], v249, s[8:11], s82 offen offset:0 nt
    buffer_load_dwordx4 v[216:219], v248, s[8:11], s82 offen offset:2048 nt
    buffer_load_dwordx4 v[220:223], v249, s[8:11], s82 offen offset:2048 nt
    buffer_load_dwordx4 v[224:227], v3, s[8:11], s83 offen offset:0 nt
    buffer_load_dwordx4 v[228:231], v3, s[8:11], s83 offen offset:1024 nt
    buffer_load_dwordx4 v[232:235], v3, s[8:11], s83 offen offset:2048 nt
    buffer_load_dwordx4 v[236:239], v3, s[8:11], s83 offen offset:3072 nt
    s_branch L_loop_standalone__gqa_block_cached__sampling_kernel
L_pred_standalone__gqa_block_cached__sampling_kernel:
    s_sub_u32 s61, s61, 32
    s_mov_b32 s3, s61
    s_lshr_b32 s57, s27, 1
    s_lshl_b32 s57, s57, 7
    s_lshl_b32 s58, s26, 4
    s_add_u32 s57, s57, s58
    s_add_u32 s57, s57, s68
    s_and_b32 s58, s27, 1
    s_lshl_b32 s64, s58, 11
    s_add_u32 s64, s64, s57
    s_add_u32 s64, s64, 131072
    s_lshl_b32 s65, s58, 3
    s_add_u32 s65, s65, s57
    s_add_u32 s65, s65, 196608
    v_and_b32 v64, 3, v1
    v_lshrrev_b32 v65, 4, v1
    v_lshlrev_b32 v240, 14, v64
    v_lshl_add_u32 v240, v65, 12, v240
    v_lshlrev_b32 v241, 8, v64
    v_and_b32 v66, 15, v1
    v_lshlrev_b32 v242, 4, v66
    v_and_b32 v66, 7, v1
    v_lshlrev_b32 v15, 4, v66
    v_lshrrev_b32 v66, 3, v1
    v_lshl_add_u32 v15, v66, 10, v15
    v_bfe_u32 v66, v1, 2, 2
    v_lshlrev_b32 v243, 10, v66
    v_lshl_add_u32 v243, v65, 8, v243
    v_lshl_add_u32 v243, v64, 3, v243
    s_lshl_b32 s57, s3, 12
    v_add_u32 v243, s57, v243
    v_and_b32 v66, 7, v1
    v_lshl_add_u32 v244, v65, 3, v66
    v_lshlrev_b32 v244, 4, v244
    s_lshl_b32 s57, s3, 12
    v_add_u32 v244, s57, v244
    v_lshrrev_b32 v65, 3, v1
    v_lshl_add_u32 v245, v66, 3, v65
    v_lshlrev_b32 v245, 4, v245
    s_lshl_b32 s57, s3, 10
    v_add_u32 v245, s57, v245
    v_lshlrev_b32 v246, 4, v66
    v_lshl_add_u32 v246, v65, 16, v246
    v_xor_b32 v65, s24, v65
    v_lshl_add_u32 v246, v65, 7, v246
    s_mov_b32 s16, s40
    s_and_b32 s17, s41, 0xffff
    s_mov_b32 s18, 0x400000
    s_mov_b32 s19, 0x20000
    s_lshl_b32 s48, s24, 19
    s_lshl_b32 s59, s27, 17
    s_add_u32 s48, s48, s59
    s_lshl_b32 s59, s26, 7
    s_add_u32 s48, s48, s59
    s_lshl_b32 s59, s3, 15
    s_add_u32 s48, s48, s59
    s_add_u32 s49, s48, 7168
    s_add_u32 s50, s48, 14336
    s_add_u32 s51, s48, 21504
    s_lshl_b32 s72, s27, 14
    s_lshl_b32 s59, s3, 12
    s_add_u32 s72, s72, s59
    s_add_u32 s72, s72, s68
    s_add_u32 s72, s72, 131072
    s_lshl_b32 s73, s27, 8
    s_add_u32 s73, s73, s68
    s_add_u32 s73, s73, 196608
    s_lshl_b32 s74, s26, 1
    s_add_u32 s74, s74, s3
    s_lshl_b32 s74, s74, 12
    s_lshl_b32 s59, s27, 10
    s_add_u32 s74, s74, s59
    s_add_u32 s74, s74, 1048576
    s_lshr_b32 s59, s25, 1
    s_lshl_b32 s78, s24, 4
    s_add_u32 s78, s78, s59
    s_lshl_b32 s75, s78, 12
    s_lshl_b32 s59, s3, 10
    s_add_u32 s75, s75, s59
    s_add_u32 s75, s75, 1048576
    s_lshl_b32 s78, s78, 6
    s_cmp_lg_u32 s69, 0
    s_cbranch_scc1 L_hm2_standalone__gqa_block_cached__sampling_kernel
    s_mov_b32 s60, 2097152
L_kd2_standalone__gqa_block_cached__sampling_kernel:
    ds_read_b32 v7, v11 offset:8
    s_sub_u32 s60, s60, 1
    s_waitcnt lgkmcnt(0)
    v_readfirstlane_b32 s59, v7
    s_cmp_ge_u32 s59, 16
    s_cbranch_scc1 L_kd2ok_standalone__gqa_block_cached__sampling_kernel
    s_sleep 1
    s_cmp_lg_u32 s60, 0
    s_cbranch_scc1 L_kd2_standalone__gqa_block_cached__sampling_kernel
L_kd2ok_standalone__gqa_block_cached__sampling_kernel:
    ds_read_b32 v4, v253 offset:32
    s_mov_b32 s69, 1
    s_waitcnt lgkmcnt(0)
    v_mul_f32 v5, s54, v4
L_hm2_standalone__gqa_block_cached__sampling_kernel:
    s_and_b32 s59, s79, 15
    s_lshl_b32 s59, s59, 11
    v_add_u32 v10, s59, v252
    ds_read_b128 v[32:35], v10 offset:0
    ds_read_b128 v[36:39], v10 offset:256
    ds_read_b128 v[40:43], v10 offset:512
    ds_read_b128 v[44:47], v10 offset:768
    ds_read_b128 v[48:51], v10 offset:1024
    ds_read_b128 v[52:55], v10 offset:1280
    ds_read_b128 v[56:59], v10 offset:1536
    ds_read_b128 v[60:63], v10 offset:1792
    s_waitcnt lgkmcnt(4)
    v_fma_f32 v32, v32, s54, -v5
    v_fma_f32 v33, v33, s54, -v5
    v_fma_f32 v34, v34, s54, -v5
    v_fma_f32 v35, v35, s54, -v5
    v_fma_f32 v36, v36, s54, -v5
    v_fma_f32 v37, v37, s54, -v5
    v_fma_f32 v38, v38, s54, -v5
    v_fma_f32 v39, v39, s54, -v5
    v_fma_f32 v40, v40, s54, -v5
    v_fma_f32 v41, v41, s54, -v5
    v_fma_f32 v42, v42, s54, -v5
    v_fma_f32 v43, v43, s54, -v5
    v_fma_f32 v44, v44, s54, -v5
    v_fma_f32 v45, v45, s54, -v5
    v_fma_f32 v46, v46, s54, -v5
    v_fma_f32 v47, v47, s54, -v5
    v_exp_f32 v32, v32
    v_exp_f32 v33, v33
    v_exp_f32 v34, v34
    v_exp_f32 v35, v35
    v_exp_f32 v36, v36
    v_exp_f32 v37, v37
    v_exp_f32 v38, v38
    v_exp_f32 v39, v39
    v_exp_f32 v40, v40
    v_exp_f32 v41, v41
    v_exp_f32 v42, v42
    v_exp_f32 v43, v43
    v_exp_f32 v44, v44
    v_exp_f32 v45, v45
    v_exp_f32 v46, v46
    v_exp_f32 v47, v47
    s_nop 0
    v_cvt_pk_bf16_f32 v16, v32, v33
    v_cvt_pk_bf16_f32 v17, v34, v35
    v_cvt_pk_bf16_f32 v18, v36, v37
    v_cvt_pk_bf16_f32 v19, v38, v39
    v_cvt_pk_bf16_f32 v20, v40, v41
    v_cvt_pk_bf16_f32 v21, v42, v43
    v_cvt_pk_bf16_f32 v22, v44, v45
    v_cvt_pk_bf16_f32 v23, v46, v47
    s_waitcnt lgkmcnt(0)
    v_fma_f32 v48, v48, s54, -v5
    v_fma_f32 v49, v49, s54, -v5
    v_fma_f32 v50, v50, s54, -v5
    v_fma_f32 v51, v51, s54, -v5
    v_fma_f32 v52, v52, s54, -v5
    v_fma_f32 v53, v53, s54, -v5
    v_fma_f32 v54, v54, s54, -v5
    v_fma_f32 v55, v55, s54, -v5
    v_fma_f32 v56, v56, s54, -v5
    v_fma_f32 v57, v57, s54, -v5
    v_fma_f32 v58, v58, s54, -v5
    v_fma_f32 v59, v59, s54, -v5
    v_fma_f32 v60, v60, s54, -v5
    v_fma_f32 v61, v61, s54, -v5
    v_fma_f32 v62, v62, s54, -v5
    v_fma_f32 v63, v63, s54, -v5
    v_exp_f32 v48, v48
    v_exp_f32 v49, v49
    v_exp_f32 v50, v50
    v_exp_f32 v51, v51
    v_exp_f32 v52, v52
    v_exp_f32 v53, v53
    v_exp_f32 v54, v54
    v_exp_f32 v55, v55
    v_exp_f32 v56, v56
    v_exp_f32 v57, v57
    v_exp_f32 v58, v58
    v_exp_f32 v59, v59
    v_exp_f32 v60, v60
    v_exp_f32 v61, v61
    v_exp_f32 v62, v62
    v_exp_f32 v63, v63
    s_nop 0
    v_cvt_pk_bf16_f32 v24, v48, v49
    v_cvt_pk_bf16_f32 v25, v50, v51
    v_cvt_pk_bf16_f32 v26, v52, v53
    v_cvt_pk_bf16_f32 v27, v54, v55
    v_cvt_pk_bf16_f32 v28, v56, v57
    v_cvt_pk_bf16_f32 v29, v58, v59
    v_cvt_pk_bf16_f32 v30, v60, v61
    v_cvt_pk_bf16_f32 v31, v62, v63
    s_waitcnt vmcnt(24)
    v_perm_b32 v64, v116, v112, v250
    v_perm_b32 v65, v124, v120, v250
    v_perm_b32 v66, v132, v128, s55
    v_perm_b32 v67, v140, v136, s55
    v_perm_b32 v68, v116, v112, v251
    v_perm_b32 v69, v124, v120, v251
    v_perm_b32 v70, v132, v128, s56
    v_perm_b32 v71, v140, v136, s56
    v_mfma_f32_16x16x32_bf16 v[80:83], v[64:67], v[16:19], v[80:83]
    v_perm_b32 v72, v117, v113, v250
    v_perm_b32 v73, v125, v121, v250
    v_perm_b32 v74, v133, v129, s55
    v_perm_b32 v75, v141, v137, s55
    v_mfma_f32_16x16x32_bf16 v[84:87], v[68:71], v[16:19], v[84:87]
    v_perm_b32 v76, v117, v113, v251
    v_perm_b32 v77, v125, v121, v251
    v_perm_b32 v78, v133, v129, s56
    v_perm_b32 v79, v141, v137, s56
    v_mfma_f32_16x16x32_bf16 v[88:91], v[72:75], v[16:19], v[88:91]
    v_perm_b32 v64, v118, v114, v250
    v_perm_b32 v65, v126, v122, v250
    v_perm_b32 v66, v134, v130, s55
    v_perm_b32 v67, v142, v138, s55
    v_mfma_f32_16x16x32_bf16 v[92:95], v[76:79], v[16:19], v[92:95]
    v_perm_b32 v68, v118, v114, v251
    v_perm_b32 v69, v126, v122, v251
    v_perm_b32 v70, v134, v130, s56
    v_perm_b32 v71, v142, v138, s56
    v_mfma_f32_16x16x32_bf16 v[96:99], v[64:67], v[16:19], v[96:99]
    v_perm_b32 v72, v119, v115, v250
    v_perm_b32 v73, v127, v123, v250
    v_perm_b32 v74, v135, v131, s55
    v_perm_b32 v75, v143, v139, s55
    v_mfma_f32_16x16x32_bf16 v[100:103], v[68:71], v[16:19], v[100:103]
    v_perm_b32 v76, v119, v115, v251
    v_perm_b32 v77, v127, v123, v251
    v_perm_b32 v78, v135, v131, s56
    v_perm_b32 v79, v143, v139, s56
    v_mfma_f32_16x16x32_bf16 v[104:107], v[72:75], v[16:19], v[104:107]
    s_nop 0
    v_mfma_f32_16x16x32_bf16 v[108:111], v[76:79], v[16:19], v[108:111]
    s_waitcnt vmcnt(16)
    v_perm_b32 v64, v148, v144, v250
    v_perm_b32 v65, v156, v152, v250
    v_perm_b32 v66, v164, v160, s55
    v_perm_b32 v67, v172, v168, s55
    v_perm_b32 v68, v148, v144, v251
    v_perm_b32 v69, v156, v152, v251
    v_perm_b32 v70, v164, v160, s56
    v_perm_b32 v71, v172, v168, s56
    v_mfma_f32_16x16x32_bf16 v[80:83], v[64:67], v[20:23], v[80:83]
    v_perm_b32 v72, v149, v145, v250
    v_perm_b32 v73, v157, v153, v250
    v_perm_b32 v74, v165, v161, s55
    v_perm_b32 v75, v173, v169, s55
    v_mfma_f32_16x16x32_bf16 v[84:87], v[68:71], v[20:23], v[84:87]
    v_perm_b32 v76, v149, v145, v251
    v_perm_b32 v77, v157, v153, v251
    v_perm_b32 v78, v165, v161, s56
    v_perm_b32 v79, v173, v169, s56
    v_mfma_f32_16x16x32_bf16 v[88:91], v[72:75], v[20:23], v[88:91]
    v_perm_b32 v64, v150, v146, v250
    v_perm_b32 v65, v158, v154, v250
    v_perm_b32 v66, v166, v162, s55
    v_perm_b32 v67, v174, v170, s55
    v_mfma_f32_16x16x32_bf16 v[92:95], v[76:79], v[20:23], v[92:95]
    v_perm_b32 v68, v150, v146, v251
    v_perm_b32 v69, v158, v154, v251
    v_perm_b32 v70, v166, v162, s56
    v_perm_b32 v71, v174, v170, s56
    v_mfma_f32_16x16x32_bf16 v[96:99], v[64:67], v[20:23], v[96:99]
    v_perm_b32 v72, v151, v147, v250
    v_perm_b32 v73, v159, v155, v250
    v_perm_b32 v74, v167, v163, s55
    v_perm_b32 v75, v175, v171, s55
    v_mfma_f32_16x16x32_bf16 v[100:103], v[68:71], v[20:23], v[100:103]
    v_perm_b32 v76, v151, v147, v251
    v_perm_b32 v77, v159, v155, v251
    v_perm_b32 v78, v167, v163, s56
    v_perm_b32 v79, v175, v171, s56
    v_mfma_f32_16x16x32_bf16 v[104:107], v[72:75], v[20:23], v[104:107]
    s_nop 0
    v_mfma_f32_16x16x32_bf16 v[108:111], v[76:79], v[20:23], v[108:111]
    v_add_f32 v7, v32, v33
    v_add_f32 v8, v34, v35
    v_add_f32 v7, v7, v36
    v_add_f32 v8, v8, v37
    v_add_f32 v7, v7, v38
    v_add_f32 v8, v8, v39
    v_add_f32 v7, v7, v40
    v_add_f32 v8, v8, v41
    v_add_f32 v7, v7, v42
    v_add_f32 v8, v8, v43
    v_add_f32 v7, v7, v44
    v_add_f32 v8, v8, v45
    v_add_f32 v7, v7, v46
    v_add_f32 v8, v8, v47
    v_add_f32 v7, v7, v48
    v_add_f32 v8, v8, v49
    v_add_f32 v7, v7, v50
    v_add_f32 v8, v8, v51
    v_add_f32 v7, v7, v52
    v_add_f32 v8, v8, v53
    v_add_f32 v7, v7, v54
    v_add_f32 v8, v8, v55
    v_add_f32 v7, v7, v56
    v_add_f32 v8, v8, v57
    v_add_f32 v7, v7, v58
    v_add_f32 v8, v8, v59
    v_add_f32 v7, v7, v60
    v_add_f32 v8, v8, v61
    v_add_f32 v7, v7, v62
    v_add_f32 v8, v8, v63
    v_add_f32 v7, v7, v8
    v_add_f32 v6, v6, v7
    s_cmp_eq_u32 s61, 0
    s_cbranch_scc1 L_nomg_standalone__gqa_block_cached__sampling_kernel
    s_mov_b32 s60, 2097152
L_mw_standalone__gqa_block_cached__sampling_kernel:
    ds_read_b32 v7, v11 offset:20
    s_sub_u32 s60, s60, 1
    s_waitcnt lgkmcnt(0)
    v_readfirstlane_b32 s59, v7
    s_cmp_ge_u32 s59, s61
    s_cbranch_scc1 L_mwok_standalone__gqa_block_cached__sampling_kernel
    s_sleep 0
    s_cmp_lg_u32 s60, 0
    s_cbranch_scc1 L_mw_standalone__gqa_block_cached__sampling_kernel
L_mwok_standalone__gqa_block_cached__sampling_kernel:
    v_lshlrev_b32 v10, 2, v1
    ds_read_b32 v9, v10 offset:57344
    ds_read_b128 v[32:35], v3 offset:49152
    ds_read_b128 v[36:39], v3 offset:50176
    ds_read_b128 v[40:43], v3 offset:51200
    ds_read_b128 v[44:47], v3 offset:52224
    ds_read_b128 v[48:51], v3 offset:53248
    ds_read_b128 v[52:55], v3 offset:54272
    ds_read_b128 v[56:59], v3 offset:55296
    ds_read_b128 v[60:63], v3 offset:56320
    s_waitcnt lgkmcnt(8)
    v_add_f32 v6, v6, v9
    s_waitcnt lgkmcnt(7)
    v_add_f32 v80, v80, v32
    v_add_f32 v81, v81, v33
    v_add_f32 v82, v82, v34
    v_add_f32 v83, v83, v35
    s_waitcnt lgkmcnt(6)
    v_add_f32 v84, v84, v36
    v_add_f32 v85, v85, v37
    v_add_f32 v86, v86, v38
    v_add_f32 v87, v87, v39
    s_waitcnt lgkmcnt(5)
    v_add_f32 v88, v88, v40
    v_add_f32 v89, v89, v41
    v_add_f32 v90, v90, v42
    v_add_f32 v91, v91, v43
    s_waitcnt lgkmcnt(4)
    v_add_f32 v92, v92, v44
    v_add_f32 v93, v93, v45
    v_add_f32 v94, v94, v46
    v_add_f32 v95, v95, v47
    s_waitcnt lgkmcnt(3)
    v_add_f32 v96, v96, v48
    v_add_f32 v97, v97, v49
    v_add_f32 v98, v98, v50
    v_add_f32 v99, v99, v51
    s_waitcnt lgkmcnt(2)
    v_add_f32 v100, v100, v52
    v_add_f32 v101, v101, v53
    v_add_f32 v102, v102, v54
    v_add_f32 v103, v103, v55
    s_waitcnt lgkmcnt(1)
    v_add_f32 v104, v104, v56
    v_add_f32 v105, v105, v57
    v_add_f32 v106, v106, v58
    v_add_f32 v107, v107, v59
    s_waitcnt lgkmcnt(0)
    v_add_f32 v108, v108, v60
    v_add_f32 v109, v109, v61
    v_add_f32 v110, v110, v62
    v_add_f32 v111, v111, v63
L_nomg_standalone__gqa_block_cached__sampling_kernel:
    s_waitcnt vmcnt(8)
    v_perm_b32 v64, v180, v176, v250
    v_perm_b32 v65, v188, v184, v250
    v_perm_b32 v66, v196, v192, s55
    v_perm_b32 v67, v204, v200, s55
    v_perm_b32 v68, v180, v176, v251
    v_perm_b32 v69, v188, v184, v251
    v_perm_b32 v70, v196, v192, s56
    v_perm_b32 v71, v204, v200, s56
    v_mfma_f32_16x16x32_bf16 v[80:83], v[64:67], v[24:27], v[80:83]
    v_perm_b32 v72, v181, v177, v250
    v_perm_b32 v73, v189, v185, v250
    v_perm_b32 v74, v197, v193, s55
    v_perm_b32 v75, v205, v201, s55
    v_mfma_f32_16x16x32_bf16 v[84:87], v[68:71], v[24:27], v[84:87]
    v_perm_b32 v76, v181, v177, v251
    v_perm_b32 v77, v189, v185, v251
    v_perm_b32 v78, v197, v193, s56
    v_perm_b32 v79, v205, v201, s56
    v_mfma_f32_16x16x32_bf16 v[88:91], v[72:75], v[24:27], v[88:91]
    v_perm_b32 v64, v182, v178, v250
    v_perm_b32 v65, v190, v186, v250
    v_perm_b32 v66, v198, v194, s55
    v_perm_b32 v67, v206, v202, s55
    v_mfma_f32_16x16x32_bf16 v[92:95], v[76:79], v[24:27], v[92:95]
    v_perm_b32 v68, v182, v178, v251
    v_perm_b32 v69, v190, v186, v251
    v_perm_b32 v70, v198, v194, s56
    v_perm_b32 v71, v206, v202, s56
    v_mfma_f32_16x16x32_bf16 v[96:99], v[64:67], v[24:27], v[96:99]
    v_perm_b32 v72, v183, v179, v250
    v_perm_b32 v73, v191, v187, v250
    v_perm_b32 v74, v199, v195, s55
    v_perm_b32 v75, v207, v203, s55
    v_mfma_f32_16x16x32_bf16 v[100:103], v[68:71], v[24:27], v[100:103]
    v_perm_b32 v76, v183, v179, v251
    v_perm_b32 v77, v191, v187, v251
    v_perm_b32 v78, v199, v195, s56
    v_perm_b32 v79, v207, v203, s56
    v_mfma_f32_16x16x32_bf16 v[104:107], v[72:75], v[24:27], v[104:107]
    s_nop 0
    v_mfma_f32_16x16x32_bf16 v[108:111], v[76:79], v[24:27], v[108:111]
    v_mov_b32 v9, v6
    v_mov_b32 v8, v6
    s_nop 1
    v_permlane16_swap_b32 v9, v8
    v_add_f32 v9, v9, v8
    v_mov_b32 v8, v9
    s_nop 1
    v_permlane32_swap_b32 v9, v8
    v_add_f32 v9, v9, v8
    v_mov_b32 v8, v5
    s_waitcnt vmcnt(0)
    v_perm_b32 v64, v212, v208, v250
    v_perm_b32 v65, v220, v216, v250
    v_perm_b32 v66, v228, v224, s55
    v_perm_b32 v67, v236, v232, s55
    v_perm_b32 v68, v212, v208, v251
    v_perm_b32 v69, v220, v216, v251
    v_perm_b32 v70, v228, v224, s56
    v_perm_b32 v71, v236, v232, s56
    v_mfma_f32_16x16x32_bf16 v[80:83], v[64:67], v[28:31], v[80:83]
    v_perm_b32 v72, v213, v209, v250
    v_perm_b32 v73, v221, v217, v250
    v_perm_b32 v74, v229, v225, s55
    v_perm_b32 v75, v237, v233, s55
    v_mfma_f32_16x16x32_bf16 v[84:87], v[68:71], v[28:31], v[84:87]
    v_perm_b32 v76, v213, v209, v251
    v_perm_b32 v77, v221, v217, v251
    v_perm_b32 v78, v229, v225, s56
    v_perm_b32 v79, v237, v233, s56
    v_mfma_f32_16x16x32_bf16 v[88:91], v[72:75], v[28:31], v[88:91]
    v_perm_b32 v64, v214, v210, v250
    v_perm_b32 v65, v222, v218, v250
    v_perm_b32 v66, v230, v226, s55
    v_perm_b32 v67, v238, v234, s55
    v_mfma_f32_16x16x32_bf16 v[92:95], v[76:79], v[28:31], v[92:95]
    v_perm_b32 v68, v214, v210, v251
    v_perm_b32 v69, v222, v218, v251
    v_perm_b32 v70, v230, v226, s56
    v_perm_b32 v71, v238, v234, s56
    v_mfma_f32_16x16x32_bf16 v[96:99], v[64:67], v[28:31], v[96:99]
    v_perm_b32 v72, v215, v211, v250
    v_perm_b32 v73, v223, v219, v250
    v_perm_b32 v74, v231, v227, s55
    v_perm_b32 v75, v239, v235, s55
    v_mfma_f32_16x16x32_bf16 v[100:103], v[68:71], v[28:31], v[100:103]
    v_perm_b32 v76, v215, v211, v251
    v_perm_b32 v77, v223, v219, v251
    v_perm_b32 v78, v231, v227, s56
    v_perm_b32 v79, v239, v235, s56
    v_mfma_f32_16x16x32_bf16 v[104:107], v[72:75], v[28:31], v[104:107]
    s_nop 0
    v_mfma_f32_16x16x32_bf16 v[108:111], v[76:79], v[28:31], v[108:111]
    s_cmp_eq_u32 s61, 3
    s_cbranch_scc1 L_pub_standalone__gqa_block_cached__sampling_kernel
    v_lshlrev_b32 v10, 2, v1
    s_add_u32 s61, s61, 1
    v_mov_b32 v7, s61
    ds_write_b32 v10, v6 offset:57344
    ds_write_b128 v3, v[80:83] offset:49152
    ds_write_b128 v3, v[84:87] offset:50176
    ds_write_b128 v3, v[88:91] offset:51200
    ds_write_b128 v3, v[92:95] offset:52224
    ds_write_b128 v3, v[96:99] offset:53248
    ds_write_b128 v3, v[100:103] offset:54272
    ds_write_b128 v3, v[104:107] offset:55296
    ds_write_b128 v3, v[108:111] offset:56320
    ds_write_b32 v11, v7 offset:20
    s_mov_b32 s60, 2097152
L_wow_standalone__gqa_block_cached__sampling_kernel:
    ds_read_b32 v7, v11 offset:20
    s_sub_u32 s60, s60, 1
    s_waitcnt lgkmcnt(0)
    v_readfirstlane_b32 s59, v7
    s_cmp_ge_u32 s59, 2
    s_cbranch_scc1 L_wowok_standalone__gqa_block_cached__sampling_kernel
    s_sleep 1
    s_cmp_lg_u32 s60, 0
    s_cbranch_scc1 L_wow_standalone__gqa_block_cached__sampling_kernel
L_wowok_standalone__gqa_block_cached__sampling_kernel:
    s_lshl_b32 m0, s3, 12
    s_nop 0
    buffer_load_dwordx4 v15, s[16:19], s48 offen offset:0 nt lds
    buffer_load_dwordx4 v15, s[16:19], s49 offen offset:1024 nt lds
    buffer_load_dwordx4 v15, s[16:19], s50 offen offset:2048 nt lds
    buffer_load_dwordx4 v15, s[16:19], s51 offen offset:3072 nt lds
    s_cmp_lg_u32 s3, 2
    s_cbranch_scc1 L_nwa_standalone__gqa_block_cached__sampling_kernel
    s_add_u32 s80, s48, 32768
    s_add_u32 s81, s49, 32768
    s_add_u32 s82, s50, 32768
    s_add_u32 s83, s51, 32768
    s_mov_b32 m0, 12288
    v_mov_b32 v8, 0x100
    buffer_load_dwordx4 v15, s[16:19], s80 offen offset:0 nt lds
    buffer_load_dwordx4 v15, s[16:19], s81 offen offset:1024 nt lds
    buffer_load_dwordx4 v15, s[16:19], s82 offen offset:2048 nt lds
    buffer_load_dwordx4 v15, s[16:19], s83 offen offset:3072 nt lds
    s_waitcnt vmcnt(0)
    ds_write_b32 v11, v8 offset:16
L_nwa_standalone__gqa_block_cached__sampling_kernel:
    s_mov_b32 s60, 2097152
L_hold_standalone__gqa_block_cached__sampling_kernel:
    ds_read_b32 v7, v11 offset:20
    s_sub_u32 s60, s60, 1
    s_waitcnt lgkmcnt(0)
    v_readfirstlane_b32 s59, v7
    s_cmp_ge_u32 s59, 4
    s_cbranch_scc1 L_holdok_standalone__gqa_block_cached__sampling_kernel
    s_sleep 1
    s_cmp_lg_u32 s60, 0
    s_cbranch_scc1 L_hold_standalone__gqa_block_cached__sampling_kernel
L_holdok_standalone__gqa_block_cached__sampling_kernel:
    s_branch L_pubd2_standalone__gqa_block_cached__sampling_kernel
L_pub_standalone__gqa_block_cached__sampling_kernel:
    s_cmp_eq_u32 s31, 0
    s_cbranch_scc1 L_pubs_standalone__gqa_block_cached__sampling_kernel
    s_mov_b64 exec, 0xf
    buffer_store_dwordx2 v[8:9], v241, s[12:15], s65 offen
    s_mov_b32 exec_lo, 0x000f000f
    s_mov_b32 exec_hi, 0x000f000f
    buffer_store_dwordx4 v[80:83], v240, s[12:15], s64 offen offset:0
    buffer_store_dwordx4 v[84:87], v240, s[12:15], s64 offen offset:1024
    buffer_store_dwordx4 v[88:91], v240, s[12:15], s64 offen offset:256
    buffer_store_dwordx4 v[92:95], v240, s[12:15], s64 offen offset:1280
    buffer_store_dwordx4 v[96:99], v240, s[12:15], s64 offen offset:512
    buffer_store_dwordx4 v[100:103], v240, s[12:15], s64 offen offset:1536
    buffer_store_dwordx4 v[104:107], v240, s[12:15], s64 offen offset:768
    buffer_store_dwordx4 v[108:111], v240, s[12:15], s64 offen offset:1792
    s_branch L_pube_standalone__gqa_block_cached__sampling_kernel
L_pubs_standalone__gqa_block_cached__sampling_kernel:
    s_mov_b64 exec, 0xf
    buffer_store_dwordx2 v[8:9], v241, s[12:15], s65 offen sc1
    s_mov_b32 exec_lo, 0x000f000f
    s_mov_b32 exec_hi, 0x000f000f
    buffer_store_dwordx4 v[80:83], v240, s[12:15], s64 offen offset:0 sc1
    buffer_store_dwordx4 v[84:87], v240, s[12:15], s64 offen offset:1024 sc1
    buffer_store_dwordx4 v[88:91], v240, s[12:15], s64 offen offset:256 sc1
    buffer_store_dwordx4 v[92:95], v240, s[12:15], s64 offen offset:1280 sc1
    buffer_store_dwordx4 v[96:99], v240, s[12:15], s64 offen offset:512 sc1
    buffer_store_dwordx4 v[100:103], v240, s[12:15], s64 offen offset:1536 sc1
    buffer_store_dwordx4 v[104:107], v240, s[12:15], s64 offen offset:768 sc1
    buffer_store_dwordx4 v[108:111], v240, s[12:15], s64 offen offset:1792 sc1
L_pube_standalone__gqa_block_cached__sampling_kernel:
    s_mov_b64 exec, -1
    v_mov_b32 v7, 4
    ds_write_b32 v11, v7 offset:20
L_pubd_standalone__gqa_block_cached__sampling_kernel:
    s_mov_b32 s60, 2097152
L_wa_standalone__gqa_block_cached__sampling_kernel:
    ds_read_b32 v7, v11 offset:16
    s_sub_u32 s60, s60, 1
    s_waitcnt lgkmcnt(0)
    v_readfirstlane_b32 s59, v7
    s_cmp_ge_u32 s59, 256
    s_cbranch_scc1 L_waok_standalone__gqa_block_cached__sampling_kernel
    s_sleep 0
    s_cmp_lg_u32 s60, 0
    s_cbranch_scc1 L_wa_standalone__gqa_block_cached__sampling_kernel
L_waok_standalone__gqa_block_cached__sampling_kernel:
L_pubd2_standalone__gqa_block_cached__sampling_kernel:
    buffer_load_dwordx4 v[16:19], v242, s[12:15], s73 offen sc1
    buffer_load_dwordx4 v[32:35], v3, s[12:15], s72 offen sc1
    buffer_load_dwordx4 v[36:39], v3, s[12:15], s72 offen offset:1024 sc1
    buffer_load_dwordx4 v[40:43], v3, s[12:15], s72 offen offset:2048 sc1
    buffer_load_dwordx4 v[44:47], v3, s[12:15], s72 offen offset:3072 sc1
    s_mov_b32 s20, s42
    s_and_b32 s21, s43, 0xffff
    s_mov_b32 s22, 0x2000
    s_mov_b32 s23, 0x20000
    s_mov_b32 s60, 524288
    v_mov_b32 v58, s52
    v_mov_b32 v59, s53
    v_mov_b32 v60, s44
    v_mov_b32 v61, s45
    v_mov_b32 v62, s32
    v_mov_b32 v63, s33
    s_waitcnt vmcnt(5)
    ds_read_b64_tr_b16 v[112:113], v243 offset:0
    ds_read_b64_tr_b16 v[114:115], v243 offset:128
    ds_read_b64_tr_b16 v[116:117], v243 offset:32
    ds_read_b64_tr_b16 v[118:119], v243 offset:160
    ds_read_b64_tr_b16 v[120:121], v243 offset:64
    ds_read_b64_tr_b16 v[122:123], v243 offset:192
    ds_read_b64_tr_b16 v[124:125], v243 offset:96
    ds_read_b64_tr_b16 v[126:127], v243 offset:224
    s_branch L_p1c_standalone__gqa_block_cached__sampling_kernel
L_p1_standalone__gqa_block_cached__sampling_kernel:
    buffer_load_dwordx4 v[16:19], v242, s[12:15], s73 offen sc1
    buffer_load_dwordx4 v[32:35], v3, s[12:15], s72 offen sc1
    buffer_load_dwordx4 v[36:39], v3, s[12:15], s72 offen offset:1024 sc1
    buffer_load_dwordx4 v[40:43], v3, s[12:15], s72 offen offset:2048 sc1
    buffer_load_dwordx4 v[44:47], v3, s[12:15], s72 offen offset:3072 sc1
L_p1c_standalone__gqa_block_cached__sampling_kernel:
    s_sub_u32 s60, s60, 1
    s_waitcnt vmcnt(0)
    v_max3_u32 v7, v16, v17, v18
    v_max3_u32 v8, v19, v32, v33
    v_max3_u32 v7, v7, v34, v35
    v_max3_u32 v8, v8, v36, v37
    v_max3_u32 v7, v7, v38, v39
    v_max3_u32 v8, v8, v40, v41
    v_max3_u32 v7, v7, v42, v43
    v_max3_u32 v8, v8, v44, v45
    v_max3_u32 v7, v7, v46, v47
    v_max_u32 v7, v7, v8
    v_cmp_eq_u32 vcc, -1, v7
    s_cbranch_vccz L_p1ok_standalone__gqa_block_cached__sampling_kernel
    s_mov_b64 exec, vcc
    s_sleep 1
    s_cmp_lg_u32 s60, 0
    s_cbranch_scc1 L_p1_standalone__gqa_block_cached__sampling_kernel
L_p1ok_standalone__gqa_block_cached__sampling_kernel:
    s_mov_b64 exec, -1
    v_max_f32 v20, v16, v18
    s_nop 1
    v_max_f32_dpp v20, v20, v20 row_ror:8 row_mask:0xf bank_mask:0xf
    v_sub_f32 v16, v16, v20
    v_sub_f32 v18, v18, v20
    v_exp_f32 v16, v16
    v_exp_f32 v18, v18
    s_nop 0
    v_mul_f32 v22, v16, v17
    v_fmac_f32 v22, v18, v19
    v_mul_f32 v32, v16, v32
    v_mul_f32 v33, v16, v33
    v_mul_f32 v34, v16, v34
    v_mul_f32 v35, v16, v35
    v_mul_f32 v36, v16, v36
    v_mul_f32 v37, v16, v37
    v_mul_f32 v38, v16, v38
    v_mul_f32 v39, v16, v39
    v_add_f32_dpp v22, v22, v22 row_ror:8 row_mask:0xf bank_mask:0xf
    v_fmac_f32 v32, v18, v40
    v_fmac_f32 v33, v18, v41
    v_fmac_f32 v34, v18, v42
    v_fmac_f32 v35, v18, v43
    v_fmac_f32 v36, v18, v44
    v_fmac_f32 v37, v18, v45
    v_fmac_f32 v38, v18, v46
    v_fmac_f32 v39, v18, v47
    v_rcp_f32 v22, v22
    v_add_f32_dpp v32, v32, v32 row_ror:8 row_mask:0xf bank_mask:0xf
    v_add_f32_dpp v33, v33, v33 row_ror:8 row_mask:0xf bank_mask:0xf
    v_add_f32_dpp v34, v34, v34 row_ror:8 row_mask:0xf bank_mask:0xf
    v_add_f32_dpp v35, v35, v35 row_ror:8 row_mask:0xf bank_mask:0xf
    v_add_f32_dpp v36, v36, v36 row_ror:8 row_mask:0xf bank_mask:0xf
    v_add_f32_dpp v37, v37, v37 row_ror:8 row_mask:0xf bank_mask:0xf
    v_add_f32_dpp v38, v38, v38 row_ror:8 row_mask:0xf bank_mask:0xf
    v_add_f32_dpp v39, v39, v39 row_ror:8 row_mask:0xf bank_mask:0xf
    v_mul_f32 v32, v22, v32
    v_mul_f32 v33, v22, v33
    v_mul_f32 v34, v22, v34
    v_mul_f32 v35, v22, v35
    v_mul_f32 v36, v22, v36
    v_mul_f32 v37, v22, v37
    v_mul_f32 v38, v22, v38
    v_mul_f32 v39, v22, v39
    v_cvt_pk_bf16_f32 v48, v32, v33
    v_cvt_pk_bf16_f32 v49, v34, v35
    v_cvt_pk_bf16_f32 v50, v36, v37
    v_cvt_pk_bf16_f32 v51, v38, v39
    s_waitcnt lgkmcnt(0)
    s_nop 0
    v_mfma_f32_16x16x32_bf16 v[144:147], v[112:115], v[48:51], 0
    v_mfma_f32_16x16x32_bf16 v[148:151], v[116:119], v[48:51], 0
    v_mfma_f32_16x16x32_bf16 v[152:155], v[120:123], v[48:51], 0
    v_mfma_f32_16x16x32_bf16 v[156:159], v[124:127], v[48:51], 0
    s_mov_b32 exec_lo, 0x00ff00ff
    s_mov_b32 exec_hi, 0x00ff00ff
    s_nop 2
    ds_write_b128 v244, v[144:147] offset:32768
    ds_write_b128 v244, v[148:151] offset:33280
    ds_write_b128 v244, v[152:155] offset:33792
    ds_write_b128 v244, v[156:159] offset:34304
    s_mov_b64 exec, -1
    s_waitcnt lgkmcnt(0)
    s_barrier
    s_cmp_ge_u32 s3, 2
    s_cbranch_scc1 L_nost_standalone__gqa_block_cached__sampling_kernel
    ds_read_b128 v[32:35], v245 offset:32768
    ds_read_b128 v[36:39], v245 offset:36864
    ds_read_b128 v[40:43], v245 offset:40960
    ds_read_b128 v[44:47], v245 offset:45056
    s_waitcnt lgkmcnt(2)
    v_add_f32 v32, v32, v36
    v_add_f32 v33, v33, v37
    v_add_f32 v34, v34, v38
    v_add_f32 v35, v35, v39
    s_waitcnt lgkmcnt(0)
    v_add_f32 v40, v40, v44
    v_add_f32 v41, v41, v45
    v_add_f32 v42, v42, v46
    v_add_f32 v43, v43, v47
    v_add_f32 v32, v32, v40
    v_add_f32 v33, v33, v41
    v_add_f32 v34, v34, v42
    v_add_f32 v35, v35, v43
    v_add_u32 v32, 0x200, v32
    v_add_u32 v33, 0x200, v33
    v_add_u32 v34, 0x200, v34
    v_add_u32 v35, 0x200, v35
    v_and_or_b32 v32, v32, s38, v60
    v_and_or_b32 v33, v33, s38, v61
    v_and_or_b32 v34, v34, s38, v62
    v_and_or_b32 v35, v35, s38, v63
    buffer_store_dwordx4 v[32:35], v246, s[12:15], s74 offen sc1
L_nost_standalone__gqa_block_cached__sampling_kernel:
    s_and_b32 s59, s25, 1
    s_cbranch_scc1 L_end2_standalone__gqa_block_cached__sampling_kernel
    s_mov_b32 s60, 524288
    s_lshl_b32 s59, s3, 10
    v_add_u32 v10, s59, v3
    s_waitcnt vmcnt(0)
    s_barrier
L_p2_standalone__gqa_block_cached__sampling_kernel:
    buffer_load_dwordx4 v[16:19], v3, s[12:15], s75 offen sc1
    s_sub_u32 s60, s60, 1
    s_waitcnt vmcnt(0)
    v_xor_b32 v16, v60, v16
    v_xor_b32 v17, v61, v17
    v_xor_b32 v18, v62, v18
    v_xor_b32 v19, v63, v19
    v_or3_b32 v7, v16, v17, v18
    v_or_b32 v7, v7, v19
    v_and_b32 v7, 0x3ff, v7
    v_cmp_ne_u32 vcc, 0, v7
    s_cbranch_vccz L_p2ok_standalone__gqa_block_cached__sampling_kernel
    s_mov_b64 exec, vcc
    s_sleep 1
    s_cmp_lg_u32 s60, 0
    s_cbranch_scc1 L_p2_standalone__gqa_block_cached__sampling_kernel
L_p2ok_standalone__gqa_block_cached__sampling_kernel:
    s_mov_b64 exec, -1
    ds_write_b128 v10, v[16:19] offset:49152
    s_lshl_b32 s59, s3, 3
    v_add_u32 v9, s59, v3
    s_waitcnt lgkmcnt(0)
    s_barrier
    s_cmp_ge_u32 s3, 2
    s_cbranch_scc1 L_end2_standalone__gqa_block_cached__sampling_kernel
    ds_read_b64 v[16:17], v9 offset:49152
    ds_read_b64 v[20:21], v9 offset:50176
    ds_read_b64 v[22:23], v9 offset:51200
    ds_read_b64 v[24:25], v9 offset:52224
    v_lshlrev_b32 v7, 3, v1
    s_lshl_b32 s59, s3, 2
    s_add_u32 s59, s59, s78
    s_waitcnt lgkmcnt(2)
    v_add_f32 v16, v16, v20
    v_add_f32 v17, v17, v21
    s_waitcnt lgkmcnt(0)
    v_add_f32 v22, v22, v24
    v_add_f32 v23, v23, v25
    v_add_f32 v16, v16, v22
    v_add_f32 v17, v17, v23
    s_nop 1
    v_add_f32_dpp v16, v16, v16 row_ror:8 row_mask:0xf bank_mask:0xf
    v_add_f32_dpp v17, v17, v17 row_ror:8 row_mask:0xf bank_mask:0xf
    v_mov_b32 v18, v16
    v_mov_b32 v19, v17
    s_nop 1
    v_permlane16_swap_b32 v16, v18
    v_permlane16_swap_b32 v17, v19
    v_add_f32 v16, v16, v18
    v_add_f32 v17, v17, v19
    v_mov_b32 v18, v16
    v_mov_b32 v19, v17
    s_nop 1
    v_permlane32_swap_b32 v16, v18
    v_permlane32_swap_b32 v17, v19
    v_add_f32 v16, v16, v18
    v_add_f32 v17, v17, v19
    v_cvt_pk_bf16_f32 v16, v16, v17
    s_mov_b64 exec, 0xff
    buffer_store_dword v16, v7, s[20:23], s59 offen
    s_cmp_lg_u32 s59, 0
    s_cbranch_scc1 L_fin2_standalone__gqa_block_cached__sampling_kernel
    s_mov_b64 exec, 1
    buffer_store_dwordx2 v[58:59], v7, s[12:15], 0 offen sc1
L_fin2_standalone__gqa_block_cached__sampling_kernel:
    s_mov_b64 exec, -1
L_end2_standalone__gqa_block_cached__sampling_kernel:
L_end_standalone__gqa_block_cached__sampling_kernel:
    s_endpgm
.section .rodata,"a"
.p2align 6
.amdhsa_kernel standalone__gqa_block_cached__sampling_kernel
  .amdhsa_next_free_vgpr 384
  .amdhsa_next_free_sgpr 84
  .amdhsa_accum_offset 256
  .amdhsa_group_segment_fixed_size 0
  .amdhsa_kernarg_size 64
  .amdhsa_user_sgpr_count 2
  .amdhsa_user_sgpr_kernarg_segment_ptr 1
  .amdhsa_system_sgpr_workgroup_id_x 1
.end_amdhsa_kernel
```
